```python
import torch

def _softmax(x, axis=-1):
    return torch.softmax(x, dim=axis)
def _gelu(x):
    return torch.nn.functional.gelu(x, approximate="tanh")
def _silu(x):
    return torch.nn.functional.silu(x)
def _sigmoid(x):
    return torch.sigmoid(x)
def _layernorm(x, axis=-1, eps=1e-5):
    m = x.mean(dim=axis, keepdim=True)
    v = x.var(dim=axis, keepdim=True, unbiased=False)
    return (x - m) / torch.sqrt(v + eps)
def _scatter_add(tgt, idx, src, axis=0):
    return tgt.clone().index_add_(axis, idx, src)
def _segment_sum(src, seg, n):
    out = torch.zeros((n,) + src.shape[1:], dtype=src.dtype)
    return out.index_add_(0, seg, src)
def _pad(x, pw):
    flat = tuple(v for pair in reversed(pw) for v in pair)
    return torch.nn.functional.pad(x, flat)

kernel_name = 'parallel_sum__gqa_block_cached__glu_gated_geglu__decode'

def setup_inputs():

    _w = (lambda a: (lambda t: t.to(torch.bfloat16) if t.is_floating_point() else t)(torch.as_tensor(a)))
    def _A_setup():
        B, Sq, D = 4, 1, 512
        Hq, Hkv, Sk, Dh = 32, 8, 4096, 128
        assert Hq % Hkv == 0, (Hq, Hkv)
        return {
            "x": _w((lambda *s: torch.randn(*s, dtype=torch.bfloat16) * 0.05)(B, Sq, D)),
            "k_cache": _w((lambda *s: torch.randn(*s, dtype=torch.bfloat16) * 1.6)(B, Hkv, Sk, Dh)),
            "v_cache": _w((lambda *s: torch.randn(*s, dtype=torch.bfloat16) * 0.8)(B, Hkv, Sk, Dh)),
            "wq": _w((lambda *s: torch.randn(*s, dtype=torch.bfloat16) * 1.6)(D, Hq * Dh) * (D ** -0.5)),
            "wo": _w((lambda *s: torch.randn(*s, dtype=torch.bfloat16) * 0.8)(Hq * Dh, D) * ((Hq * Dh) ** -0.5)),
        }
    _A_in = _A_setup()

    def _B_setup():
        B, S, Dm, Df = 4, 1, 512, 1792
        return {
            "x": _w((lambda *s: torch.randn(*s, dtype=torch.bfloat16) * 0.05)(B, S, Dm)),
            "w_gate": _w((lambda *s: torch.randn(*s, dtype=torch.bfloat16) * 0.4)(Dm, Df) * (Dm ** -0.5)),
            "w_up": _w((lambda *s: torch.randn(*s, dtype=torch.bfloat16) * 0.4)(Dm, Df) * (Dm ** -0.5)),
            "w_down": _w((lambda *s: torch.randn(*s, dtype=torch.bfloat16) * 0.4)(Df, Dm) * (Df ** -0.5)),
        }
    _B_in = _B_setup()

    return {
        "A_x": _A_in["x"],
        "A_k_cache": _A_in["k_cache"],
        "A_v_cache": _A_in["v_cache"],
        "A_wq": _A_in["wq"],
        "A_wo": _A_in["wo"],
        "B_x": _B_in["x"],
        "B_w_gate": _B_in["w_gate"],
        "B_w_up": _B_in["w_up"],
        "B_w_down": _B_in["w_down"],
    }

def reference(A_x, A_k_cache, A_v_cache, A_wq, A_wo, B_x, B_w_gate, B_w_up, B_w_down):
    def _A_ref(x, k_cache, v_cache, wq, wo):
        B, Sq, D = x.shape
        Hq, Dh = 32, 128
        Hkv = k_cache.shape[1]
        rep = Hq // Hkv
        q = (lambda x, *d: x.permute(*d))((x @ wq).reshape(B, Sq, Hq, Dh), 0, 2, 1, 3)
        k = (lambda x, n, axis: torch.repeat_interleave(x, n, dim=axis))(k_cache, rep, axis=1)
        v = (lambda x, n, axis: torch.repeat_interleave(x, n, dim=axis))(v_cache, rep, axis=1)
        scores = torch.einsum("bhqd,bhkd->bhqk", q, k) * (Dh ** -0.5)
        p = _softmax(scores, axis=-1)
        o = torch.einsum("bhqk,bhkd->bhqd", p, v)
        return (lambda x, *d: x.permute(*d))(o, 0, 2, 1, 3).reshape(B, Sq, Hq * Dh) @ wo

    def _B_ref(x, w_gate, w_up, w_down):
        g = torch.einsum("bsd,df->bsf", x, w_gate)
        u = torch.einsum("bsd,df->bsf", x, w_up)
        h = _gelu(g) * u
        return torch.einsum("bsf,fd->bsd", h, w_down)

    x = A_x
    xn = _layernorm(x, axis=-1)
    return x + _A_ref(xn, A_k_cache, A_v_cache, A_wq, A_wo) + _B_ref(xn, B_w_gate, B_w_up, B_w_down)
```

```asm
; @launch grid=(256,1,1) block=(512,1,1) lds=158720
.amdgcn_target "amdgcn-amd-amdhsa--gfx950"
.text
.globl parallel_sum__gqa_block_cached__glu_gated_geglu__decode_kernel
.p2align 8
.type parallel_sum__gqa_block_cached__glu_gated_geglu__decode_kernel,@function
parallel_sum__gqa_block_cached__glu_gated_geglu__decode_kernel:

    s_cmp_ge_u32 s2, 256
    s_cbranch_scc1 L_exit
    s_load_dwordx16 s[4:19], s[0:1], 0
    s_load_dwordx8 s[20:27], s[0:1], 64

    v_and_b32 v1, 63, v0
    v_lshrrev_b32 v32, 6, v0
    v_and_b32 v2, 15, v1
    v_readfirstlane_b32 s28, v32
    v_lshrrev_b32 v3, 4, v1
    v_and_b32 v4, 3, v1
    v_mov_b32 v14, 0
    v_mov_b32 v15, 1
    s_lshr_b32 s29, s2, 6
    s_bfe_u32 s30, s2, 0x30003
    s_and_b32 s75, s2, 7
    s_lshl_b32 s32, s30, 2
    s_add_u32 s32, s32, s29

    s_lshr_b32 s31, s2, 3
    s_mul_i32 s31, s31, 1
    s_add_u32 s31, s31, s2
    s_and_b32 s31, s31, 7

    s_lshl_b32 s88, s29, 3
    s_add_u32 s88, s88, s30
    s_lshl_b32 s88, s88, 3
    s_add_u32 s88, s88, s31
    s_mov_b32 s73, 0
    s_cmp_lg_u32 s28, 0
    s_cbranch_scc1 L_noinit
    v_lshlrev_b32 v32, 2, v1
    v_mov_b32 v33, 0
    s_mov_b64 exec, 0xFFFF
    ds_write_b32 v32, v33 offset:0
    s_mov_b64 exec, -1
    s_waitcnt lgkmcnt(0)

L_noinit:

    s_lshr_b32 s74, s28, 2
    s_and_b32 s28, s28, 3
    s_cmp_eq_u32 s74, 0
    s_cbranch_scc1 L_qwave

    s_setprio 3
    v_lshlrev_b32 v5, 4, v1
    s_lshl_b32 s33, s28, 10
    v_lshrrev_b32 v36, 3, v1
    v_and_b32 v37, 7, v1
    v_lshlrev_b32 v37, 4, v37
    v_lshl_add_u32 v22, v36, 13, v37
    s_lshl_b32 s35, s29, 20
    s_lshl_b32 s34, s30, 10
    s_add_u32 s35, s35, s34
    s_lshl_b32 s34, s31, 7
    s_add_u32 s37, s35, s34
    s_waitcnt lgkmcnt(0)
    s_mov_b32 s40, s4
    s_mov_b32 s41, s5
    s_mov_b32 s42, 4096
    s_mov_b32 s43, 0x20000
    buffer_load_dwordx4 v[24:27], v5, s[40:43], s33 offen
    s_add_u32 s52, s10, s37
    s_addc_u32 s53, s11, 0
    s_mov_b32 s54, 1040512
    s_mov_b32 s55, 0x20000

    s_mov_b32 s68, s26
    s_mov_b32 s69, s27
    s_mov_b32 s70, 2097152
    s_mov_b32 s71, 0x20000
    s_mov_b32 s34, 2031616
    v_mov_b32 v33, 0
    buffer_load_dword v6, v33, s[68:71], s34 offen sc1

    s_mul_i32 s34, s28, 262144
    s_mul_i32 s33, s28, 4096
    s_add_u32 s33, s33, 11264

    s_mov_b32 m0, s33
    s_nop 0
    buffer_load_dwordx4 v22, s[52:55], s34 offen nt lds

    s_add_u32 s34, s34, 65536
    s_add_u32 s33, s33, 1024

    s_mov_b32 m0, s33
    s_nop 0
    buffer_load_dwordx4 v22, s[52:55], s34 offen nt lds

    s_add_u32 s34, s34, 65536
    s_add_u32 s33, s33, 1024

    s_mov_b32 m0, s33
    s_nop 0
    buffer_load_dwordx4 v22, s[52:55], s34 offen nt lds

    s_add_u32 s34, s34, 65536
    s_add_u32 s33, s33, 1024

    s_mov_b32 m0, s33
    s_nop 0
    buffer_load_dwordx4 v22, s[52:55], s34 offen nt lds

    s_barrier

    v_mul_u32_u24 v23, 3584, v36
    v_add_u32 v23, v23, v37
    v_lshl_add_u32 v21, v36, 10, v37
    s_and_b32 s33, s75, 1
    s_cmp_eq_u32 s33, 0
    s_cselect_b32 s35, s16, s18
    s_cselect_b32 s36, s17, s19
    s_lshr_b32 s33, s75, 1
    s_mul_i32 s33, s33, 458752
    s_lshl_b32 s34, s32, 7
    s_add_u32 s33, s33, s34
    s_add_u32 s56, s35, s33
    s_addc_u32 s57, s36, 0
    s_cmp_lt_u32 s32, 28
    s_cselect_b32 s58, 455296, 0
    s_mov_b32 s59, 0x20000

    s_lshl_b32 s33, s32, 16
    s_lshl_b32 s34, s75, 7
    s_add_u32 s33, s33, s34
    s_add_u32 s60, s20, s33
    s_addc_u32 s61, s21, 0
    s_cmp_lt_u32 s32, 28
    s_cselect_b32 s62, 64640, 0
    s_mov_b32 s63, 0x20000

    s_mov_b32 s80, 0x000F000F
    s_mov_b32 s81, 0x000F000F
    s_mov_b32 s82, 0xFFFF
    s_mov_b32 s83, 0
    v_mov_b32 v7, 15
    v_lshrrev_b32 v32, 2, v2
    v_lshl_add_u32 v32, v3, 3, v32
    v_lshlrev_b32 v32, 7, v32
    v_lshl_add_u32 v34, v4, 3, v32
    s_lshl_b32 s36, s28, 5
    s_add_u32 s36, s36, 11264
    v_add_u32 v34, s36, v34
    v_mul_u32_u24 v35, 272, v4
    v_lshl_add_u32 v35, v3, 4, v35
    v_lshlrev_b32 v5, 4, v1

    s_lshl_b32 s33, s88, 17
    s_add_u32 s48, s8, s33
    s_addc_u32 s49, s9, 0
    s_mov_b32 s50, 131072
    s_mov_b32 s51, 0x20000
    s_lshl_b32 s33, s32, 17
    s_lshl_b32 s34, s75, 7
    s_add_u32 s33, s33, s34
    s_add_u32 s64, s12, s33
    s_addc_u32 s65, s13, 0
    s_mov_b32 s66, 130176
    s_mov_b32 s67, 0x20000

    v_lshlrev_b32 v36, 1, v3
    v_add_u32 v36, 0, v36
    v_xor_b32 v16, v2, v36
    v_lshlrev_b32 v16, 4, v16
    v_lshl_add_u32 v16, v3, 8, v16
    v_lshlrev_b32 v36, 1, v3
    v_add_u32 v36, 8, v36
    v_xor_b32 v17, v2, v36
    v_lshlrev_b32 v17, 4, v17
    v_lshl_add_u32 v17, v3, 8, v17

    s_and_b32 s33, s28, 1
    s_cmp_eq_u32 s33, 1
    s_cselect_b64 vcc, -1, 0
    v_cndmask_b32 v16, v16, v17, vcc

    s_lshl_b32 s37, s28, 2
    s_add_u32 s37, s37, 0
    v_mov_b32 v18, s37
    s_lshl_b32 s78, s29, 16
    s_lshl_b32 s34, s30, 11
    s_add_u32 s78, s78, s34
    s_lshl_b32 s34, s31, 8
    s_add_u32 s78, s78, s34
    s_add_u32 s78, s78, 0
    s_lshl_b32 s79, s32, 13
    s_lshl_b32 s34, s75, 10
    s_add_u32 s79, s79, s34
    s_add_u32 s79, s79, 262144
    s_lshl_b32 s34, s28, 6
    v_lshlrev_b32 v11, 14, v2
    v_lshl_add_u32 v11, v3, 4, v11
    v_add_u32 v11, s34, v11
    v_lshlrev_b32 v12, 8, v2
    v_lshl_add_u32 v12, v3, 4, v12
    v_add_u32 v12, s34, v12
    v_add_u32 v19, 0, v34
    v_add_u32 v20, 0, v34
    s_waitcnt vmcnt(4)

    v_readfirstlane_b32 s72, v6
    v_add_u32 v6, 1, v6

    v_add_u32 v112, 159, v6
    v_and_b32 v112, 15, v112
    v_add_u32 v13, 106, v6
    v_and_b32 v13, 15, v13
    v_add_u32 v8, 53, v6
    v_and_b32 v8, 15, v8
    v_and_b32 v6, 15, v6
    v_lshlrev_b32 v40, 16, v24
    v_and_b32 v41, 0xffff0000, v24
    v_lshlrev_b32 v42, 16, v25
    v_and_b32 v43, 0xffff0000, v25
    v_lshlrev_b32 v44, 16, v26
    v_and_b32 v45, 0xffff0000, v26
    v_lshlrev_b32 v46, 16, v27
    v_and_b32 v47, 0xffff0000, v27

    v_add_f32 v32, v40, v41
    v_add_f32 v33, v42, v43
    v_add_f32 v36, v44, v45
    v_add_f32 v37, v46, v47
    v_add_f32 v32, v32, v33
    v_add_f32 v36, v36, v37
    v_add_f32 v32, v32, v36

    s_nop 1
    v_add_f32_dpp v32, v32, v32 quad_perm:[1,0,3,2] row_mask:0xf bank_mask:0xf
    s_nop 1
    v_add_f32_dpp v32, v32, v32 quad_perm:[2,3,0,1] row_mask:0xf bank_mask:0xf
    s_nop 1
    v_add_f32_dpp v32, v32, v32 row_half_mirror row_mask:0xf bank_mask:0xf
    s_nop 1
    v_add_f32_dpp v32, v32, v32 row_mirror row_mask:0xf bank_mask:0xf
    s_nop 0
    v_mov_b32 v33, v32
    s_nop 1
    v_permlane16_swap_b32 v32, v33
    s_nop 0
    v_add_f32 v32, v32, v33
    v_mov_b32 v33, v32
    s_nop 1
    v_permlane32_swap_b32 v32, v33
    s_nop 0
    v_add_f32 v32, v32, v33
    v_mul_f32 v32, 0x3b000000, v32
    v_sub_f32 v48, v40, v32
    v_sub_f32 v49, v41, v32
    v_sub_f32 v50, v42, v32
    v_sub_f32 v51, v43, v32
    v_sub_f32 v52, v44, v32
    v_sub_f32 v53, v45, v32
    v_sub_f32 v54, v46, v32
    v_sub_f32 v55, v47, v32
    v_mul_f32 v33, v48, v48
    v_mul_f32 v36, v49, v49
    v_fmac_f32 v33, v50, v50
    v_fmac_f32 v36, v51, v51
    v_fmac_f32 v33, v52, v52
    v_fmac_f32 v36, v53, v53
    v_fmac_f32 v33, v54, v54
    v_fmac_f32 v36, v55, v55
    v_add_f32 v33, v33, v36
    s_nop 1
    v_add_f32_dpp v33, v33, v33 quad_perm:[1,0,3,2] row_mask:0xf bank_mask:0xf
    s_nop 1
    v_add_f32_dpp v33, v33, v33 quad_perm:[2,3,0,1] row_mask:0xf bank_mask:0xf
    s_nop 1
    v_add_f32_dpp v33, v33, v33 row_half_mirror row_mask:0xf bank_mask:0xf
    s_nop 1
    v_add_f32_dpp v33, v33, v33 row_mirror row_mask:0xf bank_mask:0xf
    s_nop 0
    v_mov_b32 v36, v33
    s_nop 1
    v_permlane16_swap_b32 v33, v36
    s_nop 0
    v_add_f32 v33, v33, v36
    v_mov_b32 v36, v33
    s_nop 1
    v_permlane32_swap_b32 v33, v36
    s_nop 0
    v_add_f32 v33, v33, v36
    v_mul_f32 v33, 0x3b000000, v33
    v_cvt_pk_bf16_f32 v32, v32, v32
    v_lshlrev_b32 v32, 16, v32
    v_cvt_pk_bf16_f32 v33, v33, v33
    v_lshlrev_b32 v33, 16, v33
    v_add_f32 v33, 0x3727c5ac, v33
    v_cvt_pk_bf16_f32 v33, v33, v33
    v_lshlrev_b32 v33, 16, v33
    v_sqrt_f32 v33, v33
    v_sub_f32 v48, v40, v32
    v_sub_f32 v49, v41, v32
    v_sub_f32 v50, v42, v32
    v_sub_f32 v51, v43, v32
    v_sub_f32 v52, v44, v32
    v_sub_f32 v53, v45, v32
    v_sub_f32 v54, v46, v32
    v_sub_f32 v55, v47, v32
    v_cvt_pk_bf16_f32 v33, v33, v33
    v_lshlrev_b32 v33, 16, v33
    v_rcp_f32 v33, v33
    v_cvt_pk_bf16_f32 v36, v48, v49
    v_lshlrev_b32 v48, 16, v36
    v_and_b32 v49, 0xffff0000, v36
    v_cvt_pk_bf16_f32 v36, v50, v51
    v_lshlrev_b32 v50, 16, v36
    v_and_b32 v51, 0xffff0000, v36
    v_cvt_pk_bf16_f32 v36, v52, v53
    v_lshlrev_b32 v52, 16, v36
    v_and_b32 v53, 0xffff0000, v36
    v_cvt_pk_bf16_f32 v36, v54, v55
    v_lshlrev_b32 v54, 16, v36
    v_and_b32 v55, 0xffff0000, v36
    v_mul_f32 v48, v48, v33
    v_mul_f32 v49, v49, v33
    v_mul_f32 v50, v50, v33
    v_mul_f32 v51, v51, v33
    v_mul_f32 v52, v52, v33
    v_mul_f32 v53, v53, v33
    v_mul_f32 v54, v54, v33
    v_mul_f32 v55, v55, v33
    v_cvt_pk_bf16_f32 v44, v48, v49
    v_cvt_pk_bf16_f32 v45, v50, v51
    v_cvt_pk_bf16_f32 v46, v52, v53
    v_cvt_pk_bf16_f32 v47, v54, v55

    s_mul_i32 s33, s28, 272
    v_lshlrev_b32 v32, 4, v2
    v_add_u32 v32, s33, v32
    v_cmp_eq_u32 vcc, s29, v3
    s_and_saveexec_b64 s[84:85], vcc
    ds_write_b128 v32, v[44:47] offset:4224
    s_mov_b64 exec, -1
    s_lshr_b32 s34, s75, 1
    v_cmp_eq_u32 vcc, s34, v3
    s_and_saveexec_b64 s[84:85], vcc
    ds_write_b128 v32, v[44:47] offset:5312
    s_mov_b64 exec, -1
    s_waitcnt vmcnt(0)

    s_mov_b64 exec, 1
    ds_add_u32 v14, v15 offset:20
    s_mov_b64 exec, -1
    s_mov_b32 s87, 0
L_sp_1:
    ds_read_b32 v252, v14 offset:20
    s_waitcnt lgkmcnt(0)

    s_nop 0
    v_readfirstlane_b32 s39, v252
    s_add_u32 s87, s87, 1
    s_cmp_ge_u32 s39, 4
    s_cbranch_scc1 L_spd_2
    s_cmp_ge_u32 s87, 200000
    s_cbranch_scc1 L_spd_2
    s_sleep 1
    s_branch L_sp_1

L_spd_2:
    ds_read_b128 v[64:67], v35 offset:4224
    ds_read_b128 v[68:71], v35 offset:4288
    ds_read_b128 v[72:75], v35 offset:4352
    ds_read_b128 v[76:79], v35 offset:4416
    ds_read_b64_tr_b16 v[48:49], v34 offset:0
    ds_read_b64_tr_b16 v[50:51], v34 offset:512
    ds_read_b64_tr_b16 v[52:53], v34 offset:4096
    ds_read_b64_tr_b16 v[54:55], v34 offset:4608
    ds_read_b64_tr_b16 v[56:57], v34 offset:8192
    ds_read_b64_tr_b16 v[58:59], v34 offset:8704
    ds_read_b64_tr_b16 v[60:61], v34 offset:12288
    ds_read_b64_tr_b16 v[62:63], v34 offset:12800
    s_waitcnt lgkmcnt(6)
    v_mfma_f32_16x16x32_bf16 v[80:83], v[48:51], v[64:67], 0
    s_waitcnt lgkmcnt(4)
    v_mfma_f32_16x16x32_bf16 v[80:83], v[52:55], v[68:71], v[80:83]
    s_waitcnt lgkmcnt(2)
    v_mfma_f32_16x16x32_bf16 v[80:83], v[56:59], v[72:75], v[80:83]
    s_waitcnt lgkmcnt(0)
    v_mfma_f32_16x16x32_bf16 v[80:83], v[60:63], v[76:79], v[80:83]
    s_nop 7
    v_bfi_b32 v80, v7, v6, v80
    v_bfi_b32 v81, v7, v8, v81
    v_bfi_b32 v82, v7, v13, v82
    v_bfi_b32 v83, v7, v112, v83

    s_mov_b64 exec, s[80:81]
    buffer_store_dwordx4 v[80:83], v11, s[68:71], s78 offen sc1
    s_mov_b64 exec, -1

    s_mov_b64 exec, 1
    ds_add_u32 v14, v15 offset:20
    s_mov_b64 exec, -1
    s_mov_b32 s87, 0
L_sp_3:
    ds_read_b32 v252, v14 offset:20
    s_waitcnt lgkmcnt(0)

    s_nop 0
    v_readfirstlane_b32 s39, v252
    s_add_u32 s87, s87, 1
    s_cmp_ge_u32 s39, 8
    s_cbranch_scc1 L_spd_4
    s_cmp_ge_u32 s87, 200000
    s_cbranch_scc1 L_spd_4
    s_sleep 1
    s_branch L_sp_3

L_spd_4:

    s_mul_i32 s34, s28, 114688
    s_mul_i32 s33, s28, 4096
    s_add_u32 s33, s33, 11264

    s_mov_b32 m0, s33
    s_nop 0
    buffer_load_dwordx4 v23, s[56:59], s34 offen nt lds

    s_add_u32 s34, s34, 28672
    s_add_u32 s33, s33, 1024

    s_mov_b32 m0, s33
    s_nop 0
    buffer_load_dwordx4 v23, s[56:59], s34 offen nt lds

    s_add_u32 s34, s34, 28672
    s_add_u32 s33, s33, 1024

    s_mov_b32 m0, s33
    s_nop 0
    buffer_load_dwordx4 v23, s[56:59], s34 offen nt lds

    s_add_u32 s34, s34, 28672
    s_add_u32 s33, s33, 1024

    s_mov_b32 m0, s33
    s_nop 0
    buffer_load_dwordx4 v23, s[56:59], s34 offen nt lds

    s_waitcnt vmcnt(0)
    s_mov_b64 exec, 1
    ds_add_u32 v14, v15 offset:20
    s_mov_b64 exec, -1
    s_mov_b32 s87, 0
L_sp_5:
    ds_read_b32 v252, v14 offset:20
    s_waitcnt lgkmcnt(0)

    s_nop 0
    v_readfirstlane_b32 s39, v252
    s_add_u32 s87, s87, 1
    s_cmp_ge_u32 s39, 12
    s_cbranch_scc1 L_spd_6
    s_cmp_ge_u32 s87, 200000
    s_cbranch_scc1 L_spd_6
    s_sleep 1
    s_branch L_sp_5

L_spd_6:
    ds_read_b128 v[64:67], v35 offset:5312
    ds_read_b128 v[68:71], v35 offset:5376
    ds_read_b128 v[72:75], v35 offset:5440
    ds_read_b128 v[76:79], v35 offset:5504
    ds_read_b64_tr_b16 v[48:49], v19 offset:0
    ds_read_b64_tr_b16 v[50:51], v19 offset:512
    ds_read_b64_tr_b16 v[52:53], v19 offset:4096
    ds_read_b64_tr_b16 v[54:55], v19 offset:4608
    ds_read_b64_tr_b16 v[56:57], v19 offset:8192
    ds_read_b64_tr_b16 v[58:59], v19 offset:8704
    ds_read_b64_tr_b16 v[60:61], v19 offset:12288
    ds_read_b64_tr_b16 v[62:63], v19 offset:12800
    s_waitcnt lgkmcnt(6)
    v_mfma_f32_16x16x32_bf16 v[80:83], v[48:51], v[64:67], 0
    s_waitcnt lgkmcnt(4)
    v_mfma_f32_16x16x32_bf16 v[80:83], v[52:55], v[68:71], v[80:83]
    s_waitcnt lgkmcnt(2)
    v_mfma_f32_16x16x32_bf16 v[80:83], v[56:59], v[72:75], v[80:83]
    s_waitcnt lgkmcnt(0)
    v_mfma_f32_16x16x32_bf16 v[80:83], v[60:63], v[76:79], v[80:83]
    s_nop 7
    v_bfi_b32 v80, v7, v6, v80
    v_bfi_b32 v81, v7, v8, v81
    v_bfi_b32 v82, v7, v13, v82
    v_bfi_b32 v83, v7, v112, v83

    s_mov_b64 exec, s[80:81]
    buffer_store_dwordx4 v[80:83], v12, s[68:71], s79 offen sc1
    s_mov_b64 exec, -1

    s_mov_b64 exec, 1
    ds_add_u32 v14, v15 offset:20
    s_mov_b64 exec, -1
    s_mov_b64 exec, 1
    ds_add_u32 v14, v15 offset:40
    s_mov_b64 exec, -1

    s_lshl_b32 s33, s29, 14
    s_lshl_b32 s34, s30, 11
    s_add_u32 s33, s33, s34
    s_lshl_b32 s34, s28, 9
    s_add_u32 s38, s33, s34
    s_add_u32 s38, s38, 0
    v_lshlrev_b32 v38, 16, v3
    v_lshl_add_u32 v38, v2, 4, v38
    s_lshl_b32 s37, s32, 13
    s_lshl_b32 s34, s28, 8
    s_add_u32 s37, s37, s34
    s_add_u32 s37, s37, 262144
    v_lshlrev_b32 v39, 10, v3
    v_lshl_add_u32 v39, v2, 4, v39
    v_add_u32 v10, 4096, v39

    buffer_load_dwordx4 v[24:27], v38, s[68:71], s38 offen sc1
    buffer_load_dwordx4 v[28:31], v38, s[68:71], s38 offen offset:256 sc1
    s_setprio 0
    s_mov_b32 s87, 0
L_sp_7:
    ds_read_b32 v252, v14 offset:36
    s_waitcnt lgkmcnt(0)

    s_nop 0
    v_readfirstlane_b32 s39, v252
    s_add_u32 s87, s87, 1
    s_cmp_ge_u32 s39, 4
    s_cbranch_scc1 L_spd_8
    s_cmp_ge_u32 s87, 200000
    s_cbranch_scc1 L_spd_8
    s_sleep 1
    s_branch L_sp_7

L_spd_8:

    s_lshl_b32 s33, s28, 10
    s_add_u32 s33, s33, 0
    s_add_u32 s34, s33, 27648
    s_mov_b32 m0, s34
    s_nop 0
    buffer_load_dwordx4 v16, s[48:51], s33 offen nt lds

    s_lshl_b32 s33, s28, 10
    s_add_u32 s33, s33, 4096
    s_add_u32 s34, s33, 27648
    s_mov_b32 m0, s34
    s_nop 0
    buffer_load_dwordx4 v16, s[48:51], s33 offen nt lds

    s_lshl_b32 s33, s28, 10
    s_add_u32 s33, s33, 8192
    s_add_u32 s34, s33, 27648
    s_mov_b32 m0, s34
    s_nop 0
    buffer_load_dwordx4 v16, s[48:51], s33 offen nt lds

    s_lshl_b32 s33, s28, 10
    s_add_u32 s33, s33, 12288
    s_add_u32 s34, s33, 27648
    s_mov_b32 m0, s34
    s_nop 0
    buffer_load_dwordx4 v16, s[48:51], s33 offen nt lds

    s_lshl_b32 s33, s28, 10
    s_add_u32 s33, s33, 16384
    s_add_u32 s34, s33, 27648
    s_mov_b32 m0, s34
    s_nop 0
    buffer_load_dwordx4 v16, s[48:51], s33 offen nt lds

    s_lshl_b32 s33, s28, 10
    s_add_u32 s33, s33, 20480
    s_add_u32 s34, s33, 27648
    s_mov_b32 m0, s34
    s_nop 0
    buffer_load_dwordx4 v16, s[48:51], s33 offen nt lds

    s_lshl_b32 s33, s28, 10
    s_add_u32 s33, s33, 24576
    s_add_u32 s34, s33, 27648
    s_mov_b32 m0, s34
    s_nop 0
    buffer_load_dwordx4 v16, s[48:51], s33 offen nt lds

    s_lshl_b32 s33, s28, 10
    s_add_u32 s33, s33, 28672
    s_add_u32 s34, s33, 27648
    s_mov_b32 m0, s34
    s_nop 0
    buffer_load_dwordx4 v16, s[48:51], s33 offen nt lds

    s_mov_b32 s86, 0
    s_waitcnt vmcnt(8)
L_q_chk:
    v_xor_b32 v24, v24, v6
    v_xor_b32 v25, v25, v8
    v_xor_b32 v26, v26, v13
    v_xor_b32 v27, v27, v112
    v_xor_b32 v28, v28, v6
    v_xor_b32 v29, v29, v8
    v_xor_b32 v30, v30, v13
    v_xor_b32 v31, v31, v112
    v_or3_b32 v41, v24, v25, v26
    v_or3_b32 v41, v41, v27, v28
    v_or3_b32 v41, v41, v29, v30
    v_or_b32 v41, v41, v31
    v_and_b32 v41, v41, v7
    v_cmp_ne_u32 vcc, 0, v41

    s_cbranch_vccz L_q_ok
    s_add_u32 s86, s86, 1
    s_cmp_ge_u32 s86, 20000
    s_cbranch_scc1 L_q_ok

    buffer_load_dwordx4 v[24:27], v38, s[68:71], s38 offen sc1
    buffer_load_dwordx4 v[28:31], v38, s[68:71], s38 offen offset:256 sc1
    s_waitcnt vmcnt(0)
    s_branch L_q_chk
L_q_ok:
    v_mov_b32 v40, v24
    v_mov_b32 v41, v25
    v_mov_b32 v42, v26
    v_mov_b32 v43, v27
    v_mov_b32 v44, v28
    v_mov_b32 v45, v29
    v_mov_b32 v46, v30
    v_mov_b32 v47, v31
    s_nop 1
    v_permlane16_swap_b32 v24, v40
    v_permlane16_swap_b32 v25, v41
    v_permlane16_swap_b32 v26, v42
    v_permlane16_swap_b32 v27, v43
    v_permlane16_swap_b32 v28, v44
    v_permlane16_swap_b32 v29, v45
    v_permlane16_swap_b32 v30, v46
    v_permlane16_swap_b32 v31, v47
    s_nop 0
    v_add_f32 v24, v24, v40
    v_add_f32 v25, v25, v41
    v_add_f32 v26, v26, v42
    v_add_f32 v27, v27, v43
    v_add_f32 v28, v28, v44
    v_add_f32 v29, v29, v45
    v_add_f32 v30, v30, v46
    v_add_f32 v31, v31, v47
    v_mov_b32 v40, v24
    v_mov_b32 v41, v25
    v_mov_b32 v42, v26
    v_mov_b32 v43, v27
    v_mov_b32 v44, v28
    v_mov_b32 v45, v29
    v_mov_b32 v46, v30
    v_mov_b32 v47, v31
    s_nop 1
    v_permlane32_swap_b32 v24, v40
    v_permlane32_swap_b32 v25, v41
    v_permlane32_swap_b32 v26, v42
    v_permlane32_swap_b32 v27, v43
    v_permlane32_swap_b32 v28, v44
    v_permlane32_swap_b32 v29, v45
    v_permlane32_swap_b32 v30, v46
    v_permlane32_swap_b32 v31, v47
    s_nop 0
    v_add_f32 v24, v24, v40
    v_add_f32 v25, v25, v41
    v_add_f32 v26, v26, v42
    v_add_f32 v27, v27, v43
    v_add_f32 v28, v28, v44
    v_add_f32 v29, v29, v45
    v_add_f32 v30, v30, v46
    v_add_f32 v31, v31, v47

    v_cvt_pk_bf16_f32 v42, v24, v25
    v_cvt_pk_bf16_f32 v43, v26, v27
    v_cvt_pk_bf16_f32 v44, v28, v29
    v_cvt_pk_bf16_f32 v45, v30, v31
    s_mul_i32 s33, s28, 272
    s_add_u32 s33, s33, 6400
    v_lshlrev_b32 v41, 3, v2
    v_add_u32 v41, s33, v41
    s_mov_b64 exec, s[82:83]
    ds_write_b64 v41, v[42:43]
    ds_write_b64 v41, v[44:45] offset:128
    s_mov_b64 exec, -1

    s_mov_b64 exec, 1
    ds_add_u32 v14, v15 offset:24
    s_mov_b64 exec, -1
    s_mov_b32 s87, 0
L_sp_9:
    ds_read_b32 v252, v14 offset:36
    s_waitcnt lgkmcnt(0)

    s_nop 0
    v_readfirstlane_b32 s39, v252
    s_add_u32 s87, s87, 1
    s_cmp_ge_u32 s39, 8
    s_cbranch_scc1 L_spd_10
    s_cmp_ge_u32 s87, 200000
    s_cbranch_scc1 L_spd_10
    s_sleep 1
    s_branch L_sp_9

L_spd_10:

    s_lshl_b32 s33, s28, 10
    s_add_u32 s33, s33, 32768
    s_add_u32 s34, s33, 27648
    s_mov_b32 m0, s34
    s_nop 0
    buffer_load_dwordx4 v16, s[48:51], s33 offen nt lds

    s_lshl_b32 s33, s28, 10
    s_add_u32 s33, s33, 36864
    s_add_u32 s34, s33, 27648
    s_mov_b32 m0, s34
    s_nop 0
    buffer_load_dwordx4 v16, s[48:51], s33 offen nt lds

    s_lshl_b32 s33, s28, 10
    s_add_u32 s33, s33, 40960
    s_add_u32 s34, s33, 27648
    s_mov_b32 m0, s34
    s_nop 0
    buffer_load_dwordx4 v16, s[48:51], s33 offen nt lds

    s_lshl_b32 s33, s28, 10
    s_add_u32 s33, s33, 45056
    s_add_u32 s34, s33, 27648
    s_mov_b32 m0, s34
    s_nop 0
    buffer_load_dwordx4 v16, s[48:51], s33 offen nt lds

    s_lshl_b32 s33, s28, 10
    s_add_u32 s33, s33, 49152
    s_add_u32 s34, s33, 27648
    s_mov_b32 m0, s34
    s_nop 0
    buffer_load_dwordx4 v16, s[48:51], s33 offen nt lds

    s_lshl_b32 s33, s28, 10
    s_add_u32 s33, s33, 53248
    s_add_u32 s34, s33, 27648
    s_mov_b32 m0, s34
    s_nop 0
    buffer_load_dwordx4 v16, s[48:51], s33 offen nt lds

    s_lshl_b32 s33, s28, 10
    s_add_u32 s33, s33, 57344
    s_add_u32 s34, s33, 27648
    s_mov_b32 m0, s34
    s_nop 0
    buffer_load_dwordx4 v16, s[48:51], s33 offen nt lds

    s_lshl_b32 s33, s28, 10
    s_add_u32 s33, s33, 61440
    s_add_u32 s34, s33, 27648
    s_mov_b32 m0, s34
    s_nop 0
    buffer_load_dwordx4 v16, s[48:51], s33 offen nt lds

    s_mov_b32 s87, 0
L_sp_11:
    ds_read_b32 v252, v14 offset:20
    s_waitcnt lgkmcnt(0)

    s_nop 0
    v_readfirstlane_b32 s39, v252
    s_add_u32 s87, s87, 1
    s_cmp_ge_u32 s39, 16
    s_cbranch_scc1 L_spd_12
    s_cmp_ge_u32 s87, 200000
    s_cbranch_scc1 L_spd_12
    s_sleep 1
    s_branch L_sp_11

L_spd_12:

    s_mul_i32 s34, s28, 16384
    s_mul_i32 s33, s28, 2048
    s_add_u32 s33, s33, 11264

    s_mov_b32 m0, s33
    s_nop 0
    buffer_load_dwordx4 v21, s[60:63], s34 offen nt lds

    s_add_u32 s34, s34, 8192
    s_add_u32 s33, s33, 1024

    s_mov_b32 m0, s33
    s_nop 0
    buffer_load_dwordx4 v21, s[60:63], s34 offen nt lds

    buffer_load_dwordx4 v[92:95], v39, s[68:71], s37 offen sc1
    buffer_load_dwordx4 v[96:99], v10, s[68:71], s37 offen sc1
    s_mov_b32 s87, 0
L_sp_13:
    ds_read_b32 v252, v14 offset:36
    s_waitcnt lgkmcnt(0)

    s_nop 0
    v_readfirstlane_b32 s39, v252
    s_add_u32 s87, s87, 1
    s_cmp_ge_u32 s39, 12
    s_cbranch_scc1 L_spd_14
    s_cmp_ge_u32 s87, 200000
    s_cbranch_scc1 L_spd_14
    s_sleep 1
    s_branch L_sp_13

L_spd_14:

    s_lshl_b32 s33, s28, 10
    s_add_u32 s33, s33, 65536
    s_add_u32 s34, s33, 27648
    s_mov_b32 m0, s34
    s_nop 0
    buffer_load_dwordx4 v16, s[48:51], s33 offen nt lds

    s_lshl_b32 s33, s28, 10
    s_add_u32 s33, s33, 69632
    s_add_u32 s34, s33, 27648
    s_mov_b32 m0, s34
    s_nop 0
    buffer_load_dwordx4 v16, s[48:51], s33 offen nt lds

    s_lshl_b32 s33, s28, 10
    s_add_u32 s33, s33, 73728
    s_add_u32 s34, s33, 27648
    s_mov_b32 m0, s34
    s_nop 0
    buffer_load_dwordx4 v16, s[48:51], s33 offen nt lds

    s_lshl_b32 s33, s28, 10
    s_add_u32 s33, s33, 77824
    s_add_u32 s34, s33, 27648
    s_mov_b32 m0, s34
    s_nop 0
    buffer_load_dwordx4 v16, s[48:51], s33 offen nt lds

    s_waitcnt vmcnt(16)
    v_mov_b32 v9, 1
    ds_write_b32 v18, v9

    s_lshl_b32 s33, s28, 10
    s_add_u32 s33, s33, 81920
    s_add_u32 s34, s33, 27648
    s_mov_b32 m0, s34
    s_nop 0
    buffer_load_dwordx4 v16, s[48:51], s33 offen nt lds

    s_lshl_b32 s33, s28, 10
    s_add_u32 s33, s33, 86016
    s_add_u32 s34, s33, 27648
    s_mov_b32 m0, s34
    s_nop 0
    buffer_load_dwordx4 v16, s[48:51], s33 offen nt lds

    s_lshl_b32 s33, s28, 10
    s_add_u32 s33, s33, 90112
    s_add_u32 s34, s33, 27648
    s_mov_b32 m0, s34
    s_nop 0
    buffer_load_dwordx4 v16, s[48:51], s33 offen nt lds

    s_lshl_b32 s33, s28, 10
    s_add_u32 s33, s33, 94208
    s_add_u32 s34, s33, 27648
    s_mov_b32 m0, s34
    s_nop 0
    buffer_load_dwordx4 v16, s[48:51], s33 offen nt lds

    s_waitcnt vmcnt(12)
    v_mov_b32 v9, 2
    ds_write_b32 v18, v9
    s_waitcnt vmcnt(10)
    s_mov_b64 exec, 1
    ds_add_u32 v14, v15 offset:20
    s_mov_b64 exec, -1
    s_mov_b32 s87, 0
L_sp_15:
    ds_read_b32 v252, v14 offset:20
    s_waitcnt lgkmcnt(0)

    s_nop 0
    v_readfirstlane_b32 s39, v252
    s_add_u32 s87, s87, 1
    s_cmp_ge_u32 s39, 20
    s_cbranch_scc1 L_spd_16
    s_cmp_ge_u32 s87, 200000
    s_cbranch_scc1 L_spd_16
    s_sleep 1
    s_branch L_sp_15

L_spd_16:
    ds_read_b64_tr_b16 v[84:85], v20 offset:0
    ds_read_b64_tr_b16 v[86:87], v20 offset:512
    ds_read_b64_tr_b16 v[88:89], v20 offset:4096
    ds_read_b64_tr_b16 v[90:91], v20 offset:4608
    s_mov_b64 exec, 1
    ds_add_u32 v14, v15 offset:20
    s_mov_b64 exec, -1
    s_mov_b32 s87, 0
L_sp_17:
    ds_read_b32 v252, v14 offset:36
    s_waitcnt lgkmcnt(0)

    s_nop 0
    v_readfirstlane_b32 s39, v252
    s_add_u32 s87, s87, 1
    s_cmp_ge_u32 s39, 16
    s_cbranch_scc1 L_spd_18
    s_cmp_ge_u32 s87, 200000
    s_cbranch_scc1 L_spd_18
    s_sleep 1
    s_branch L_sp_17

L_spd_18:

    s_lshl_b32 s33, s28, 10
    s_add_u32 s33, s33, 98304
    s_add_u32 s34, s33, 27648
    s_mov_b32 m0, s34
    s_nop 0
    buffer_load_dwordx4 v16, s[48:51], s33 offen nt lds

    s_lshl_b32 s33, s28, 10
    s_add_u32 s33, s33, 102400
    s_add_u32 s34, s33, 27648
    s_mov_b32 m0, s34
    s_nop 0
    buffer_load_dwordx4 v16, s[48:51], s33 offen nt lds

    s_lshl_b32 s33, s28, 10
    s_add_u32 s33, s33, 106496
    s_add_u32 s34, s33, 27648
    s_mov_b32 m0, s34
    s_nop 0
    buffer_load_dwordx4 v16, s[48:51], s33 offen nt lds

    s_lshl_b32 s33, s28, 10
    s_add_u32 s33, s33, 110592
    s_add_u32 s34, s33, 27648
    s_mov_b32 m0, s34
    s_nop 0
    buffer_load_dwordx4 v16, s[48:51], s33 offen nt lds

    s_lshl_b32 s33, s28, 10
    s_add_u32 s33, s33, 114688
    s_add_u32 s34, s33, 27648
    s_mov_b32 m0, s34
    s_nop 0
    buffer_load_dwordx4 v16, s[48:51], s33 offen nt lds

    s_lshl_b32 s33, s28, 10
    s_add_u32 s33, s33, 118784
    s_add_u32 s34, s33, 27648
    s_mov_b32 m0, s34
    s_nop 0
    buffer_load_dwordx4 v16, s[48:51], s33 offen nt lds

    s_lshl_b32 s33, s28, 10
    s_add_u32 s33, s33, 122880
    s_add_u32 s34, s33, 27648
    s_mov_b32 m0, s34
    s_nop 0
    buffer_load_dwordx4 v16, s[48:51], s33 offen nt lds

    s_lshl_b32 s33, s28, 10
    s_add_u32 s33, s33, 126976
    s_add_u32 s34, s33, 27648
    s_mov_b32 m0, s34
    s_nop 0
    buffer_load_dwordx4 v16, s[48:51], s33 offen nt lds

    s_mov_b32 s87, 0
L_sp_19:
    ds_read_b32 v252, v14 offset:20
    s_waitcnt lgkmcnt(0)

    s_nop 0
    v_readfirstlane_b32 s39, v252
    s_add_u32 s87, s87, 1
    s_cmp_ge_u32 s39, 24
    s_cbranch_scc1 L_spd_20
    s_cmp_ge_u32 s87, 200000
    s_cbranch_scc1 L_spd_20
    s_sleep 1
    s_branch L_sp_19

L_spd_20:

    s_mul_i32 s34, s28, 32768
    s_mul_i32 s33, s28, 4096
    s_add_u32 s33, s33, 11264

    s_mov_b32 m0, s33
    s_nop 0
    buffer_load_dwordx4 v21, s[64:67], s34 offen nt lds

    s_add_u32 s34, s34, 8192
    s_add_u32 s33, s33, 1024

    s_mov_b32 m0, s33
    s_nop 0
    buffer_load_dwordx4 v21, s[64:67], s34 offen nt lds

    s_add_u32 s34, s34, 8192
    s_add_u32 s33, s33, 1024

    s_mov_b32 m0, s33
    s_nop 0
    buffer_load_dwordx4 v21, s[64:67], s34 offen nt lds

    s_add_u32 s34, s34, 8192
    s_add_u32 s33, s33, 1024

    s_mov_b32 m0, s33
    s_nop 0
    buffer_load_dwordx4 v21, s[64:67], s34 offen nt lds

    s_waitcnt vmcnt(12)
    v_mov_b32 v9, 3
    ds_write_b32 v18, v9
    s_mov_b32 s86, 0
    s_waitcnt vmcnt(20)
L_g_chk:
    v_xor_b32 v92, v92, v6
    v_xor_b32 v93, v93, v8
    v_xor_b32 v94, v94, v13
    v_xor_b32 v95, v95, v112
    v_xor_b32 v96, v96, v6
    v_xor_b32 v97, v97, v8
    v_xor_b32 v98, v98, v13
    v_xor_b32 v99, v99, v112
    v_or3_b32 v44, v92, v93, v94
    v_or3_b32 v44, v44, v95, v96
    v_or3_b32 v44, v44, v97, v98
    v_or_b32 v44, v44, v99
    v_and_b32 v44, v44, v7
    v_cmp_ne_u32 vcc, 0, v44

    s_cbranch_vccz L_g_ok
    s_add_u32 s86, s86, 1
    s_cmp_ge_u32 s86, 20000
    s_cbranch_scc1 L_g_ok

    buffer_load_dwordx4 v[92:95], v39, s[68:71], s37 offen sc1
    buffer_load_dwordx4 v[96:99], v10, s[68:71], s37 offen sc1
    s_waitcnt vmcnt(0)
    s_branch L_g_chk
L_g_ok:
    v_add_f32 v92, v92, v96
    v_add_f32 v93, v93, v97
    v_add_f32 v94, v94, v98
    v_add_f32 v95, v95, v99
    v_mov_b32 v44, v92
    v_mov_b32 v45, v93
    v_mov_b32 v46, v94
    v_mov_b32 v47, v95
    s_nop 1
    v_permlane32_swap_b32 v92, v44
    v_permlane32_swap_b32 v93, v45
    v_permlane32_swap_b32 v94, v46
    v_permlane32_swap_b32 v95, v47
    s_nop 0
    v_add_f32 v92, v92, v44
    v_add_f32 v93, v93, v45
    v_add_f32 v94, v94, v46
    v_add_f32 v95, v95, v47
    v_mov_b32 v96, v92
    v_mov_b32 v97, v93
    v_mov_b32 v98, v94
    v_mov_b32 v99, v95
    s_nop 1
    v_permlane16_swap_b32 v92, v96
    v_permlane16_swap_b32 v93, v97
    v_permlane16_swap_b32 v94, v98
    v_permlane16_swap_b32 v95, v99
    s_nop 0
    v_cvt_pk_bf16_f32 v92, v92, v92
    v_lshlrev_b32 v92, 16, v92
    v_cvt_pk_bf16_f32 v96, v96, v96
    v_lshlrev_b32 v96, 16, v96
    v_cvt_pk_bf16_f32 v93, v93, v93
    v_lshlrev_b32 v93, 16, v93
    v_cvt_pk_bf16_f32 v97, v97, v97
    v_lshlrev_b32 v97, 16, v97
    v_cvt_pk_bf16_f32 v94, v94, v94
    v_lshlrev_b32 v94, 16, v94
    v_cvt_pk_bf16_f32 v98, v98, v98
    v_lshlrev_b32 v98, 16, v98
    v_cvt_pk_bf16_f32 v95, v95, v95
    v_lshlrev_b32 v95, 16, v95
    v_cvt_pk_bf16_f32 v99, v99, v99
    v_lshlrev_b32 v99, 16, v99
    v_mul_f32 v44, v92, v92
    v_mul_f32 v45, v93, v93
    v_mul_f32 v46, v94, v94
    v_mul_f32 v47, v95, v95
    v_mul_f32 v44, v44, v92
    v_mul_f32 v45, v45, v93
    v_mul_f32 v46, v46, v94
    v_mul_f32 v47, v47, v95
    v_mul_f32 v44, 0x3d372713, v44
    v_mul_f32 v45, 0x3d372713, v45
    v_mul_f32 v46, 0x3d372713, v46
    v_mul_f32 v47, 0x3d372713, v47
    v_add_f32 v44, v44, v92
    v_add_f32 v45, v45, v93
    v_add_f32 v46, v46, v94
    v_add_f32 v47, v47, v95
    v_mul_f32 v44, 0xc0135761, v44
    v_mul_f32 v45, 0xc0135761, v45
    v_mul_f32 v46, 0xc0135761, v46
    v_mul_f32 v47, 0xc0135761, v47
    v_exp_f32 v44, v44
    v_exp_f32 v45, v45
    v_exp_f32 v46, v46
    v_exp_f32 v47, v47
    s_nop 0
    v_add_f32 v44, 1.0, v44
    v_add_f32 v45, 1.0, v45
    v_add_f32 v46, 1.0, v46
    v_add_f32 v47, 1.0, v47
    v_rcp_f32 v44, v44
    v_rcp_f32 v45, v45
    v_rcp_f32 v46, v46
    v_rcp_f32 v47, v47
    s_nop 0
    v_mul_f32 v92, v92, v44
    v_mul_f32 v93, v93, v45
    v_mul_f32 v94, v94, v46
    v_mul_f32 v95, v95, v47
    v_cvt_pk_bf16_f32 v92, v92, v92
    v_lshlrev_b32 v92, 16, v92
    v_cvt_pk_bf16_f32 v93, v93, v93
    v_lshlrev_b32 v93, 16, v93
    v_cvt_pk_bf16_f32 v94, v94, v94
    v_lshlrev_b32 v94, 16, v94
    v_cvt_pk_bf16_f32 v95, v95, v95
    v_lshlrev_b32 v95, 16, v95
    v_mul_f32 v92, v92, v96
    v_mul_f32 v93, v93, v97
    v_mul_f32 v94, v94, v98
    v_mul_f32 v95, v95, v99

    v_cvt_pk_bf16_f32 v44, v92, v93
    v_cvt_pk_bf16_f32 v45, v94, v95
    s_mul_i32 s33, s28, 144
    v_lshlrev_b32 v47, 3, v2
    v_add_u32 v47, s33, v47
    s_mov_b64 exec, s[82:83]
    ds_write_b64 v47, v[44:45] offset:8576
    s_mov_b64 exec, -1

    s_mov_b64 exec, 1
    ds_add_u32 v14, v15 offset:20
    s_mov_b64 exec, -1
    s_mov_b32 s87, 0
L_sp_21:
    ds_read_b32 v252, v14 offset:20
    s_waitcnt lgkmcnt(0)

    s_nop 0
    v_readfirstlane_b32 s39, v252
    s_add_u32 s87, s87, 1
    s_cmp_ge_u32 s39, 28
    s_cbranch_scc1 L_spd_22
    s_cmp_ge_u32 s87, 200000
    s_cbranch_scc1 L_spd_22
    s_sleep 1
    s_branch L_sp_21

L_spd_22:

    v_mul_u32_u24 v47, 144, v4
    v_lshl_add_u32 v47, v3, 4, v47

    ds_read_b128 v[64:67], v47 offset:8576
    ds_read_b128 v[68:71], v47 offset:8640
    s_waitcnt lgkmcnt(0)
    v_mfma_f32_16x16x32_bf16 v[80:83], v[84:87], v[64:67], 0
    v_mfma_f32_16x16x32_bf16 v[80:83], v[88:91], v[68:71], v[80:83]

    s_lshl_b32 s33, s28, 8
    v_lshlrev_b32 v47, 2, v4
    v_add_u32 v47, v47, v3
    v_lshlrev_b32 v47, 4, v47
    v_add_u32 v47, s33, v47
    s_nop 3
    s_mov_b64 exec, s[80:81]
    ds_write_b128 v47, v[80:83] offset:9664
    s_mov_b64 exec, -1

    s_mov_b64 exec, 1
    ds_add_u32 v14, v15 offset:28
    s_mov_b64 exec, -1
    s_waitcnt vmcnt(8)
    v_mov_b32 v9, 4
    ds_write_b32 v18, v9
    s_waitcnt vmcnt(4)
    v_mov_b32 v9, 5
    ds_write_b32 v18, v9
    s_waitcnt vmcnt(0)
    v_mov_b32 v9, 6
    ds_write_b32 v18, v9
    s_waitcnt lgkmcnt(0)
    s_branch L_end
L_qwave:
    s_setprio 1

    s_lshl_b32 s33, s28, 12
    v_lshlrev_b32 v16, 8, v2
    v_lshl_add_u32 v16, v3, 4, v16
    v_add_u32 v16, s33, v16
    s_lshl_b32 s33, s88, 17
    s_waitcnt lgkmcnt(0)
    s_add_u32 s44, s6, s33
    s_addc_u32 s45, s7, 0
    s_mov_b32 s46, 131072
    s_mov_b32 s47, 0x20000

    s_barrier
    v_add_u32 v32, 0, v3
    v_xor_b32 v52, v2, v32
    v_lshlrev_b32 v52, 4, v52
    v_lshl_add_u32 v52, v3, 8, v52
    v_add_u32 v32, 4, v3
    v_xor_b32 v53, v2, v32
    v_lshlrev_b32 v53, 4, v53
    v_lshl_add_u32 v53, v3, 8, v53
    v_add_u32 v32, 8, v3
    v_xor_b32 v54, v2, v32
    v_lshlrev_b32 v54, 4, v54
    v_lshl_add_u32 v54, v3, 8, v54
    v_add_u32 v32, 12, v3
    v_xor_b32 v55, v2, v32
    v_lshlrev_b32 v55, 4, v55
    v_lshl_add_u32 v55, v3, 8, v55

    s_lshl_b32 s33, s28, 12
    s_add_u32 s33, s33, 0
    s_add_u32 s34, s33, 27648
    s_mov_b32 m0, s34
    s_nop 0

    buffer_load_dwordx4 v52, s[44:47], s33 offen offset:0 nt lds
    buffer_load_dwordx4 v53, s[44:47], s33 offen offset:1024 nt lds
    buffer_load_dwordx4 v54, s[44:47], s33 offen offset:2048 nt lds
    buffer_load_dwordx4 v55, s[44:47], s33 offen offset:3072 nt lds

    s_mov_b32 s68, s26
    s_mov_b32 s69, s27
    s_mov_b32 s70, 2097152
    s_mov_b32 s71, 0x20000
    s_mov_b32 s34, 2031616
    v_mov_b32 v33, 0
    buffer_load_dword v6, v33, s[68:71], s34 offen sc1

    s_lshl_b32 s33, s28, 12
    s_add_u32 s33, s33, 16384
    s_add_u32 s34, s33, 27648
    s_mov_b32 m0, s34
    s_nop 0

    buffer_load_dwordx4 v52, s[44:47], s33 offen offset:0 nt lds
    buffer_load_dwordx4 v53, s[44:47], s33 offen offset:1024 nt lds
    buffer_load_dwordx4 v54, s[44:47], s33 offen offset:2048 nt lds
    buffer_load_dwordx4 v55, s[44:47], s33 offen offset:3072 nt lds

    s_lshl_b32 s33, s28, 12
    s_add_u32 s33, s33, 32768
    s_add_u32 s34, s33, 27648
    s_mov_b32 m0, s34
    s_nop 0

    buffer_load_dwordx4 v52, s[44:47], s33 offen offset:0 nt lds
    buffer_load_dwordx4 v53, s[44:47], s33 offen offset:1024 nt lds
    buffer_load_dwordx4 v54, s[44:47], s33 offen offset:2048 nt lds
    buffer_load_dwordx4 v55, s[44:47], s33 offen offset:3072 nt lds

    s_lshl_b32 s33, s28, 12
    s_add_u32 s33, s33, 49152
    s_add_u32 s34, s33, 27648
    s_mov_b32 m0, s34
    s_nop 0

    buffer_load_dwordx4 v52, s[44:47], s33 offen offset:0 nt lds
    buffer_load_dwordx4 v53, s[44:47], s33 offen offset:1024 nt lds
    buffer_load_dwordx4 v54, s[44:47], s33 offen offset:2048 nt lds
    buffer_load_dwordx4 v55, s[44:47], s33 offen offset:3072 nt lds

    s_lshl_b32 s33, s28, 12
    s_add_u32 s33, s33, 65536
    s_add_u32 s34, s33, 27648
    s_mov_b32 m0, s34
    s_nop 0

    buffer_load_dwordx4 v52, s[44:47], s33 offen offset:0 nt lds
    buffer_load_dwordx4 v53, s[44:47], s33 offen offset:1024 nt lds
    buffer_load_dwordx4 v54, s[44:47], s33 offen offset:2048 nt lds
    buffer_load_dwordx4 v55, s[44:47], s33 offen offset:3072 nt lds

    s_lshl_b32 s33, s28, 12
    s_add_u32 s33, s33, 81920
    s_add_u32 s34, s33, 27648
    s_mov_b32 m0, s34
    s_nop 0

    buffer_load_dwordx4 v52, s[44:47], s33 offen offset:0 nt lds
    buffer_load_dwordx4 v53, s[44:47], s33 offen offset:1024 nt lds
    buffer_load_dwordx4 v54, s[44:47], s33 offen offset:2048 nt lds
    buffer_load_dwordx4 v55, s[44:47], s33 offen offset:3072 nt lds

    s_lshl_b32 s33, s28, 12
    s_add_u32 s33, s33, 27648
    v_lshlrev_b32 v32, 8, v2
    v_add_u32 v32, s33, v32

    v_add_u32 v33, 0, v3
    v_xor_b32 v33, v33, v2
    v_lshl_add_u32 v56, v33, 4, v32
    v_add_u32 v60, 65536, v56
    v_add_u32 v33, 4, v3
    v_xor_b32 v33, v33, v2
    v_lshl_add_u32 v57, v33, 4, v32
    v_add_u32 v61, 65536, v57
    v_add_u32 v33, 8, v3
    v_xor_b32 v33, v33, v2
    v_lshl_add_u32 v58, v33, 4, v32
    v_add_u32 v62, 65536, v58
    v_add_u32 v33, 12, v3
    v_xor_b32 v33, v33, v2
    v_lshl_add_u32 v59, v33, 4, v32
    v_add_u32 v63, 65536, v59
    s_waitcnt vmcnt(16)
    ds_read_b128 v[64:67], v56 offset:0
    ds_read_b128 v[68:71], v57 offset:0
    ds_read_b128 v[72:75], v58 offset:0
    ds_read_b128 v[76:79], v59 offset:0
    ds_read_b128 v[80:83], v56 offset:16384
    ds_read_b128 v[84:87], v57 offset:16384
    ds_read_b128 v[88:91], v58 offset:16384
    ds_read_b128 v[92:95], v59 offset:16384
    s_mov_b64 exec, 1
    ds_add_u32 v14, v15 offset:36
    s_mov_b64 exec, -1

    s_lshl_b32 s33, s28, 12
    s_add_u32 s33, s33, 98304
    s_add_u32 s34, s33, 27648
    s_mov_b32 m0, s34
    s_nop 0

    buffer_load_dwordx4 v52, s[44:47], s33 offen offset:0 nt lds
    buffer_load_dwordx4 v53, s[44:47], s33 offen offset:1024 nt lds
    buffer_load_dwordx4 v54, s[44:47], s33 offen offset:2048 nt lds
    buffer_load_dwordx4 v55, s[44:47], s33 offen offset:3072 nt lds

    s_lshl_b32 s33, s28, 12
    s_add_u32 s33, s33, 114688
    s_add_u32 s34, s33, 27648
    s_mov_b32 m0, s34
    s_nop 0

    buffer_load_dwordx4 v52, s[44:47], s33 offen offset:0 nt lds
    buffer_load_dwordx4 v53, s[44:47], s33 offen offset:1024 nt lds
    buffer_load_dwordx4 v54, s[44:47], s33 offen offset:2048 nt lds
    buffer_load_dwordx4 v55, s[44:47], s33 offen offset:3072 nt lds

    s_mov_b32 s80, 0x000F000F
    s_mov_b32 s81, 0x000F000F
    s_mov_b32 s82, 0xFFFF
    s_mov_b32 s83, 0
    v_mov_b32 v7, 15
    v_lshrrev_b32 v32, 2, v2
    v_lshl_add_u32 v32, v3, 3, v32
    v_lshlrev_b32 v32, 7, v32
    v_lshl_add_u32 v34, v4, 3, v32
    s_lshl_b32 s36, s28, 5
    s_add_u32 s36, s36, 11264
    v_add_u32 v34, s36, v34
    v_mul_u32_u24 v35, 272, v4
    v_lshl_add_u32 v35, v3, 4, v35
    v_lshlrev_b32 v5, 4, v1

    s_mov_b32 s40, s4
    s_mov_b32 s41, s5
    s_mov_b32 s42, 4096
    s_mov_b32 s43, 0x20000
    s_mov_b32 s76, s22
    s_mov_b32 s77, s23
    s_mov_b32 s78, 4096
    s_mov_b32 s79, 0x20000
    s_lshl_b32 s66, s30, 16
    s_lshl_b32 s34, s29, 12
    s_add_u32 s66, s66, s34
    s_lshl_b32 s34, s31, 9
    s_add_u32 s66, s66, s34
    s_add_u32 s66, s66, 524288
    s_lshl_b32 s67, s75, 15
    s_lshl_b32 s34, s32, 8
    s_add_u32 s67, s67, s34
    s_add_u32 s67, s67, 1114112
    s_lshl_b32 s60, s30, 11
    s_lshl_b32 s34, s29, 9
    s_add_u32 s60, s60, s34
    s_lshl_b32 s34, s31, 6
    s_add_u32 s60, s60, s34
    s_add_u32 s60, s60, 1048576
    s_lshl_b32 s34, s28, 7
    v_lshlrev_b32 v11, 14, v2
    v_lshl_add_u32 v11, v3, 4, v11
    v_add_u32 v11, s34, v11
    s_lshl_b32 s34, s28, 6
    v_lshlrev_b32 v13, 13, v2
    v_lshl_add_u32 v13, v3, 4, v13
    v_add_u32 v13, s34, v13

    v_mul_u32_u24 v41, 1040, v4
    v_lshl_add_u32 v41, v3, 4, v41
    v_add_u32 v41, 64, v41
    v_lshrrev_b32 v42, 2, v2
    v_lshl_add_u32 v42, v3, 2, v42
    v_and_b32 v43, 7, v42
    v_lshlrev_b32 v43, 1, v43
    v_lshrrev_b32 v44, 1, v4
    s_lshl_b32 s33, s28, 2
    v_add_u32 v44, s33, v44
    v_xor_b32 v45, v44, v43
    v_lshlrev_b32 v45, 4, v45
    v_lshl_add_u32 v45, v42, 8, v45
    v_and_b32 v48, 1, v4
    v_lshl_add_u32 v20, v48, 3, v45
    v_add_u32 v20, 27648, v20
    v_add_u32 v21, 65536, v20
    v_add_u32 v44, 2, v44
    v_xor_b32 v45, v44, v43
    v_lshlrev_b32 v45, 4, v45
    v_lshl_add_u32 v45, v42, 8, v45
    v_lshl_add_u32 v22, v48, 3, v45
    v_add_u32 v22, 27648, v22
    v_add_u32 v23, 65536, v22
    v_lshlrev_b32 v40, 2, v2
    s_lshl_b32 s33, s28, 6
    v_add_u32 v39, s33, v40
    s_lshl_b32 s33, s28, 8
    s_lshr_b32 s34, s28, 1
    s_lshl_b32 s34, s34, 6
    s_and_b32 s35, s28, 1
    s_lshl_b32 s35, s35, 3
    s_add_u32 s34, s34, s35
    s_cmp_eq_u32 s34, s34
    s_cselect_b32 s33, s34, s33
    v_mul_u32_u24 v38, 1040, v2
    v_lshl_add_u32 v38, v3, 4, v38
    v_add_u32 v38, s33, v38

    v_readfirstlane_b32 s72, v6
    v_add_u32 v6, 1, v6

    v_add_u32 v10, 159, v6
    v_and_b32 v10, 15, v10
    v_add_u32 v9, 106, v6
    v_and_b32 v9, 15, v9
    v_add_u32 v8, 53, v6
    v_and_b32 v8, 15, v8
    v_and_b32 v6, 15, v6
    s_add_u32 s33, s72, 1
    s_nop 0
    v_mov_b32 v12, s33
    v_not_b32 v17, v12
    s_waitcnt vmcnt(20)
    ds_read_b128 v[96:99], v56 offset:32768
    ds_read_b128 v[100:103], v57 offset:32768
    ds_read_b128 v[104:107], v58 offset:32768
    ds_read_b128 v[108:111], v59 offset:32768
    s_waitcnt vmcnt(16)
    ds_read_b128 v[112:115], v56 offset:49152
    ds_read_b128 v[116:119], v57 offset:49152
    ds_read_b128 v[120:123], v58 offset:49152
    ds_read_b128 v[124:127], v59 offset:49152
    s_mov_b64 exec, 1
    ds_add_u32 v14, v15 offset:36
    s_mov_b64 exec, -1
    s_waitcnt vmcnt(12)
    ds_read_b128 v[128:131], v60 offset:0
    ds_read_b128 v[132:135], v61 offset:0
    ds_read_b128 v[136:139], v62 offset:0
    ds_read_b128 v[140:143], v63 offset:0
    s_waitcnt vmcnt(8)
    ds_read_b128 v[144:147], v60 offset:16384
    ds_read_b128 v[148:151], v61 offset:16384
    ds_read_b128 v[152:155], v62 offset:16384
    ds_read_b128 v[156:159], v63 offset:16384
    s_mov_b64 exec, 1
    ds_add_u32 v14, v15 offset:36
    s_mov_b64 exec, -1
    s_waitcnt vmcnt(4)
    ds_read_b128 v[160:163], v60 offset:32768
    ds_read_b128 v[164:167], v61 offset:32768
    ds_read_b128 v[168:171], v62 offset:32768
    ds_read_b128 v[172:175], v63 offset:32768
    s_waitcnt vmcnt(0)
    ds_read_b128 v[176:179], v60 offset:49152
    ds_read_b128 v[180:183], v61 offset:49152
    ds_read_b128 v[184:187], v62 offset:49152
    ds_read_b128 v[188:191], v63 offset:49152
    s_mov_b64 exec, 1
    ds_add_u32 v14, v15 offset:36
    s_mov_b64 exec, -1
    s_mov_b32 s87, 0
L_sp_23:
    ds_read_b32 v252, v14 offset:24
    s_waitcnt lgkmcnt(0)

    s_nop 0
    v_readfirstlane_b32 s39, v252
    s_add_u32 s87, s87, 1
    s_cmp_ge_u32 s39, 4
    s_cbranch_scc1 L_spd_24
    s_cmp_ge_u32 s87, 200000
    s_cbranch_scc1 L_spd_24
    s_sleep 1
    s_branch L_sp_23

L_spd_24:
    ds_read_b128 v[48:51], v35 offset:6400
    ds_read_b128 v[52:55], v35 offset:6464
    ds_read_b128 v[56:59], v35 offset:6528
    ds_read_b128 v[60:63], v35 offset:6592
    s_waitcnt lgkmcnt(0)
    v_mfma_f32_16x16x32_bf16 v[192:195], v[64:67], v[48:51], 0
    v_mfma_f32_16x16x32_bf16 v[196:199], v[80:83], v[48:51], 0
    v_mfma_f32_16x16x32_bf16 v[192:195], v[68:71], v[52:55], v[192:195]
    v_mfma_f32_16x16x32_bf16 v[196:199], v[84:87], v[52:55], v[196:199]
    v_mfma_f32_16x16x32_bf16 v[192:195], v[72:75], v[56:59], v[192:195]
    v_mfma_f32_16x16x32_bf16 v[196:199], v[88:91], v[56:59], v[196:199]
    v_mfma_f32_16x16x32_bf16 v[192:195], v[76:79], v[60:63], v[192:195]
    v_mfma_f32_16x16x32_bf16 v[196:199], v[92:95], v[60:63], v[196:199]
    v_mfma_f32_16x16x32_bf16 v[200:203], v[96:99], v[48:51], 0
    v_mfma_f32_16x16x32_bf16 v[204:207], v[112:115], v[48:51], 0
    v_mfma_f32_16x16x32_bf16 v[200:203], v[100:103], v[52:55], v[200:203]
    v_mfma_f32_16x16x32_bf16 v[204:207], v[116:119], v[52:55], v[204:207]
    v_mfma_f32_16x16x32_bf16 v[200:203], v[104:107], v[56:59], v[200:203]
    v_mfma_f32_16x16x32_bf16 v[204:207], v[120:123], v[56:59], v[204:207]
    v_mfma_f32_16x16x32_bf16 v[200:203], v[108:111], v[60:63], v[200:203]
    v_mfma_f32_16x16x32_bf16 v[204:207], v[124:127], v[60:63], v[204:207]

    v_cvt_pk_bf16_f32 v42, v192, v193
    v_lshlrev_b32 v192, 16, v42
    v_and_b32 v193, 0xffff0000, v42
    v_mul_f32 v192, 0x3db504f3, v192
    v_mul_f32 v193, 0x3db504f3, v193
    v_cvt_pk_bf16_f32 v42, v192, v193
    v_lshlrev_b32 v192, 16, v42
    v_and_b32 v193, 0xffff0000, v42

    v_cvt_pk_bf16_f32 v42, v194, v195
    v_lshlrev_b32 v194, 16, v42
    v_and_b32 v195, 0xffff0000, v42
    v_mul_f32 v194, 0x3db504f3, v194
    v_mul_f32 v195, 0x3db504f3, v195
    v_cvt_pk_bf16_f32 v42, v194, v195
    v_lshlrev_b32 v194, 16, v42
    v_and_b32 v195, 0xffff0000, v42

    v_cvt_pk_bf16_f32 v42, v196, v197
    v_lshlrev_b32 v196, 16, v42
    v_and_b32 v197, 0xffff0000, v42
    v_mul_f32 v196, 0x3db504f3, v196
    v_mul_f32 v197, 0x3db504f3, v197
    v_cvt_pk_bf16_f32 v42, v196, v197
    v_lshlrev_b32 v196, 16, v42
    v_and_b32 v197, 0xffff0000, v42

    v_cvt_pk_bf16_f32 v42, v198, v199
    v_lshlrev_b32 v198, 16, v42
    v_and_b32 v199, 0xffff0000, v42
    v_mul_f32 v198, 0x3db504f3, v198
    v_mul_f32 v199, 0x3db504f3, v199
    v_cvt_pk_bf16_f32 v42, v198, v199
    v_lshlrev_b32 v198, 16, v42
    v_and_b32 v199, 0xffff0000, v42

    v_mfma_f32_16x16x32_bf16 v[208:211], v[128:131], v[48:51], 0
    v_mfma_f32_16x16x32_bf16 v[212:215], v[144:147], v[48:51], 0
    v_mfma_f32_16x16x32_bf16 v[208:211], v[132:135], v[52:55], v[208:211]
    v_mfma_f32_16x16x32_bf16 v[212:215], v[148:151], v[52:55], v[212:215]
    v_mfma_f32_16x16x32_bf16 v[208:211], v[136:139], v[56:59], v[208:211]
    v_mfma_f32_16x16x32_bf16 v[212:215], v[152:155], v[56:59], v[212:215]
    v_mfma_f32_16x16x32_bf16 v[208:211], v[140:143], v[60:63], v[208:211]
    v_mfma_f32_16x16x32_bf16 v[212:215], v[156:159], v[60:63], v[212:215]

    v_cvt_pk_bf16_f32 v42, v200, v201
    v_lshlrev_b32 v200, 16, v42
    v_and_b32 v201, 0xffff0000, v42
    v_mul_f32 v200, 0x3db504f3, v200
    v_mul_f32 v201, 0x3db504f3, v201
    v_cvt_pk_bf16_f32 v42, v200, v201
    v_lshlrev_b32 v200, 16, v42
    v_and_b32 v201, 0xffff0000, v42

    v_cvt_pk_bf16_f32 v42, v202, v203
    v_lshlrev_b32 v202, 16, v42
    v_and_b32 v203, 0xffff0000, v42
    v_mul_f32 v202, 0x3db504f3, v202
    v_mul_f32 v203, 0x3db504f3, v203
    v_cvt_pk_bf16_f32 v42, v202, v203
    v_lshlrev_b32 v202, 16, v42
    v_and_b32 v203, 0xffff0000, v42

    v_cvt_pk_bf16_f32 v42, v204, v205
    v_lshlrev_b32 v204, 16, v42
    v_and_b32 v205, 0xffff0000, v42
    v_mul_f32 v204, 0x3db504f3, v204
    v_mul_f32 v205, 0x3db504f3, v205
    v_cvt_pk_bf16_f32 v42, v204, v205
    v_lshlrev_b32 v204, 16, v42
    v_and_b32 v205, 0xffff0000, v42

    v_cvt_pk_bf16_f32 v42, v206, v207
    v_lshlrev_b32 v206, 16, v42
    v_and_b32 v207, 0xffff0000, v42
    v_mul_f32 v206, 0x3db504f3, v206
    v_mul_f32 v207, 0x3db504f3, v207
    v_cvt_pk_bf16_f32 v42, v206, v207
    v_lshlrev_b32 v206, 16, v42
    v_and_b32 v207, 0xffff0000, v42

    v_mfma_f32_16x16x32_bf16 v[216:219], v[160:163], v[48:51], 0
    v_mfma_f32_16x16x32_bf16 v[220:223], v[176:179], v[48:51], 0
    v_mfma_f32_16x16x32_bf16 v[216:219], v[164:167], v[52:55], v[216:219]
    v_mfma_f32_16x16x32_bf16 v[220:223], v[180:183], v[52:55], v[220:223]
    v_mfma_f32_16x16x32_bf16 v[216:219], v[168:171], v[56:59], v[216:219]
    v_mfma_f32_16x16x32_bf16 v[220:223], v[184:187], v[56:59], v[220:223]
    v_mfma_f32_16x16x32_bf16 v[216:219], v[172:175], v[60:63], v[216:219]
    v_mfma_f32_16x16x32_bf16 v[220:223], v[188:191], v[60:63], v[220:223]

    v_cvt_pk_bf16_f32 v42, v208, v209
    v_lshlrev_b32 v208, 16, v42
    v_and_b32 v209, 0xffff0000, v42
    v_mul_f32 v208, 0x3db504f3, v208
    v_mul_f32 v209, 0x3db504f3, v209
    v_cvt_pk_bf16_f32 v42, v208, v209
    v_lshlrev_b32 v208, 16, v42
    v_and_b32 v209, 0xffff0000, v42

    v_cvt_pk_bf16_f32 v42, v210, v211
    v_lshlrev_b32 v210, 16, v42
    v_and_b32 v211, 0xffff0000, v42
    v_mul_f32 v210, 0x3db504f3, v210
    v_mul_f32 v211, 0x3db504f3, v211
    v_cvt_pk_bf16_f32 v42, v210, v211
    v_lshlrev_b32 v210, 16, v42
    v_and_b32 v211, 0xffff0000, v42

    v_cvt_pk_bf16_f32 v42, v212, v213
    v_lshlrev_b32 v212, 16, v42
    v_and_b32 v213, 0xffff0000, v42
    v_mul_f32 v212, 0x3db504f3, v212
    v_mul_f32 v213, 0x3db504f3, v213
    v_cvt_pk_bf16_f32 v42, v212, v213
    v_lshlrev_b32 v212, 16, v42
    v_and_b32 v213, 0xffff0000, v42

    v_cvt_pk_bf16_f32 v42, v214, v215
    v_lshlrev_b32 v214, 16, v42
    v_and_b32 v215, 0xffff0000, v42
    v_mul_f32 v214, 0x3db504f3, v214
    v_mul_f32 v215, 0x3db504f3, v215
    v_cvt_pk_bf16_f32 v42, v214, v215
    v_lshlrev_b32 v214, 16, v42
    v_and_b32 v215, 0xffff0000, v42

    s_nop 7

    v_cvt_pk_bf16_f32 v42, v216, v217
    v_lshlrev_b32 v216, 16, v42
    v_and_b32 v217, 0xffff0000, v42
    v_mul_f32 v216, 0x3db504f3, v216
    v_mul_f32 v217, 0x3db504f3, v217
    v_cvt_pk_bf16_f32 v42, v216, v217
    v_lshlrev_b32 v216, 16, v42
    v_and_b32 v217, 0xffff0000, v42

    v_cvt_pk_bf16_f32 v42, v218, v219
    v_lshlrev_b32 v218, 16, v42
    v_and_b32 v219, 0xffff0000, v42
    v_mul_f32 v218, 0x3db504f3, v218
    v_mul_f32 v219, 0x3db504f3, v219
    v_cvt_pk_bf16_f32 v42, v218, v219
    v_lshlrev_b32 v218, 16, v42
    v_and_b32 v219, 0xffff0000, v42

    v_cvt_pk_bf16_f32 v42, v220, v221
    v_lshlrev_b32 v220, 16, v42
    v_and_b32 v221, 0xffff0000, v42
    v_mul_f32 v220, 0x3db504f3, v220
    v_mul_f32 v221, 0x3db504f3, v221
    v_cvt_pk_bf16_f32 v42, v220, v221
    v_lshlrev_b32 v220, 16, v42
    v_and_b32 v221, 0xffff0000, v42

    v_cvt_pk_bf16_f32 v42, v222, v223
    v_lshlrev_b32 v222, 16, v42
    v_and_b32 v223, 0xffff0000, v42
    v_mul_f32 v222, 0x3db504f3, v222
    v_mul_f32 v223, 0x3db504f3, v223
    v_cvt_pk_bf16_f32 v42, v222, v223
    v_lshlrev_b32 v222, 16, v42
    v_and_b32 v223, 0xffff0000, v42

    v_max3_f32 v43, v192, v193, v194
    v_max3_f32 v44, v195, v196, v197
    v_max3_f32 v43, v43, v198, v199
    v_max3_f32 v44, v44, v200, v201
    v_max3_f32 v43, v43, v202, v203
    v_max3_f32 v44, v44, v204, v205
    v_max3_f32 v43, v43, v206, v207
    v_max3_f32 v44, v44, v208, v209
    v_max3_f32 v43, v43, v210, v211
    v_max3_f32 v44, v44, v212, v213
    v_max3_f32 v43, v43, v214, v215
    v_max3_f32 v44, v44, v216, v217
    v_max3_f32 v43, v43, v218, v219
    v_max3_f32 v44, v44, v220, v221
    v_max3_f32 v43, v43, v222, v223
    v_max_f32 v43, v43, v44
    v_mov_b32 v42, v43
    s_nop 1
    v_permlane16_swap_b32 v43, v42
    s_nop 0
    v_max_f32 v43, v43, v42
    v_mov_b32 v42, v43
    s_nop 1
    v_permlane32_swap_b32 v43, v42
    s_nop 0
    v_max_f32 v43, v43, v42

    s_mov_b64 exec, s[82:83]
    ds_write_b32 v39, v43 offset:9152
    s_mov_b64 exec, -1

    s_mov_b64 exec, 1
    ds_add_u32 v14, v15 offset:16
    s_mov_b64 exec, -1
    s_mov_b32 s87, 0
L_sp_25:
    ds_read_b32 v252, v14 offset:16
    s_waitcnt lgkmcnt(0)

    s_nop 0
    v_readfirstlane_b32 s39, v252
    s_add_u32 s87, s87, 1
    s_cmp_ge_u32 s39, 4
    s_cbranch_scc1 L_spd_26
    s_cmp_ge_u32 s87, 200000
    s_cbranch_scc1 L_spd_26
    s_sleep 1
    s_branch L_sp_25

L_spd_26:
    ds_read_b32 v48, v40 offset:9152
    ds_read_b32 v49, v40 offset:9216
    ds_read_b32 v50, v40 offset:9280
    ds_read_b32 v51, v40 offset:9344

    s_mov_b32 s34, 0x3fb8aa3b
    s_waitcnt lgkmcnt(0)
    v_max3_f32 v46, v48, v49, v50
    v_max_f32 v46, v46, v51
    v_mul_f32 v47, s34, v46

    v_fma_f32 v192, v192, s34, -v47
    v_fma_f32 v193, v193, s34, -v47
    v_fma_f32 v194, v194, s34, -v47
    v_fma_f32 v195, v195, s34, -v47
    v_fma_f32 v196, v196, s34, -v47
    v_fma_f32 v197, v197, s34, -v47
    v_fma_f32 v198, v198, s34, -v47
    v_fma_f32 v199, v199, s34, -v47
    v_fma_f32 v200, v200, s34, -v47
    v_fma_f32 v201, v201, s34, -v47
    v_fma_f32 v202, v202, s34, -v47
    v_fma_f32 v203, v203, s34, -v47
    v_fma_f32 v204, v204, s34, -v47
    v_fma_f32 v205, v205, s34, -v47
    v_fma_f32 v206, v206, s34, -v47
    v_fma_f32 v207, v207, s34, -v47
    v_fma_f32 v208, v208, s34, -v47
    v_fma_f32 v209, v209, s34, -v47
    v_fma_f32 v210, v210, s34, -v47
    v_fma_f32 v211, v211, s34, -v47
    v_fma_f32 v212, v212, s34, -v47
    v_fma_f32 v213, v213, s34, -v47
    v_fma_f32 v214, v214, s34, -v47
    v_fma_f32 v215, v215, s34, -v47
    v_fma_f32 v216, v216, s34, -v47
    v_fma_f32 v217, v217, s34, -v47
    v_fma_f32 v218, v218, s34, -v47
    v_fma_f32 v219, v219, s34, -v47
    v_fma_f32 v220, v220, s34, -v47
    v_fma_f32 v221, v221, s34, -v47
    v_fma_f32 v222, v222, s34, -v47
    v_fma_f32 v223, v223, s34, -v47
    v_exp_f32 v192, v192
    v_exp_f32 v193, v193
    v_exp_f32 v194, v194
    v_exp_f32 v195, v195
    v_exp_f32 v196, v196
    v_exp_f32 v197, v197
    v_exp_f32 v198, v198
    v_exp_f32 v199, v199
    v_exp_f32 v200, v200
    v_exp_f32 v201, v201
    v_exp_f32 v202, v202
    v_exp_f32 v203, v203
    v_exp_f32 v204, v204
    v_exp_f32 v205, v205
    v_exp_f32 v206, v206
    v_exp_f32 v207, v207
    v_exp_f32 v208, v208
    v_exp_f32 v209, v209
    v_exp_f32 v210, v210
    v_exp_f32 v211, v211
    v_exp_f32 v212, v212
    v_exp_f32 v213, v213
    v_exp_f32 v214, v214
    v_exp_f32 v215, v215
    v_exp_f32 v216, v216
    v_exp_f32 v217, v217
    v_exp_f32 v218, v218
    v_exp_f32 v219, v219
    v_exp_f32 v220, v220
    v_exp_f32 v221, v221
    v_exp_f32 v222, v222
    v_exp_f32 v223, v223
    v_cvt_pk_bf16_f32 v224, v192, v193
    v_cvt_pk_bf16_f32 v225, v194, v195
    v_cvt_pk_bf16_f32 v226, v196, v197
    v_cvt_pk_bf16_f32 v227, v198, v199
    v_cvt_pk_bf16_f32 v228, v200, v201
    v_cvt_pk_bf16_f32 v229, v202, v203
    v_cvt_pk_bf16_f32 v230, v204, v205
    v_cvt_pk_bf16_f32 v231, v206, v207
    v_cvt_pk_bf16_f32 v232, v208, v209
    v_cvt_pk_bf16_f32 v233, v210, v211
    v_cvt_pk_bf16_f32 v234, v212, v213
    v_cvt_pk_bf16_f32 v235, v214, v215
    v_cvt_pk_bf16_f32 v236, v216, v217
    v_cvt_pk_bf16_f32 v237, v218, v219
    v_cvt_pk_bf16_f32 v238, v220, v221
    v_cvt_pk_bf16_f32 v239, v222, v223
    s_mov_b64 exec, s[80:81]
    ds_write_b64 v38, v[224:225] offset:64
    ds_write_b64 v38, v[226:227] offset:192
    ds_write_b64 v38, v[228:229] offset:320
    ds_write_b64 v38, v[230:231] offset:448
    ds_write_b64 v38, v[232:233] offset:576
    ds_write_b64 v38, v[234:235] offset:704
    ds_write_b64 v38, v[236:237] offset:832
    ds_write_b64 v38, v[238:239] offset:960
    s_mov_b64 exec, -1
    v_add_f32 v43, v192, v193
    v_add_f32 v42, v194, v195
    v_add_f32 v43, v43, v196
    v_add_f32 v42, v42, v197
    v_add_f32 v43, v43, v198
    v_add_f32 v42, v42, v199
    v_add_f32 v43, v43, v200
    v_add_f32 v42, v42, v201
    v_add_f32 v43, v43, v202
    v_add_f32 v42, v42, v203
    v_add_f32 v43, v43, v204
    v_add_f32 v42, v42, v205
    v_add_f32 v43, v43, v206
    v_add_f32 v42, v42, v207
    v_add_f32 v43, v43, v208
    v_add_f32 v42, v42, v209
    v_add_f32 v43, v43, v210
    v_add_f32 v42, v42, v211
    v_add_f32 v43, v43, v212
    v_add_f32 v42, v42, v213
    v_add_f32 v43, v43, v214
    v_add_f32 v42, v42, v215
    v_add_f32 v43, v43, v216
    v_add_f32 v42, v42, v217
    v_add_f32 v43, v43, v218
    v_add_f32 v42, v42, v219
    v_add_f32 v43, v43, v220
    v_add_f32 v42, v42, v221
    v_add_f32 v43, v43, v222
    v_add_f32 v42, v42, v223
    v_add_f32 v43, v43, v42
    v_mov_b32 v42, v43
    s_nop 1
    v_permlane16_swap_b32 v43, v42
    s_nop 0
    v_add_f32 v43, v43, v42
    v_mov_b32 v42, v43
    s_nop 1
    v_permlane32_swap_b32 v43, v42
    s_nop 0
    v_add_f32 v43, v43, v42

    s_mov_b64 exec, s[82:83]
    ds_write_b32 v39, v43 offset:9408
    s_mov_b64 exec, -1

    s_mov_b64 exec, 1
    ds_add_u32 v14, v15 offset:16
    s_mov_b64 exec, -1
    s_mov_b32 s87, 0
L_sp_27:
    ds_read_b32 v252, v14 offset:16
    s_waitcnt lgkmcnt(0)

    s_nop 0
    v_readfirstlane_b32 s39, v252
    s_add_u32 s87, s87, 1
    s_cmp_ge_u32 s39, 8
    s_cbranch_scc1 L_spd_28
    s_cmp_ge_u32 s87, 200000
    s_cbranch_scc1 L_spd_28
    s_sleep 1
    s_branch L_sp_27

L_spd_28:
    ds_read_b32 v48, v40 offset:9408
    ds_read_b32 v49, v40 offset:9472
    ds_read_b32 v50, v40 offset:9536
    ds_read_b32 v51, v40 offset:9600

    s_waitcnt lgkmcnt(0)
    v_add_f32 v47, v48, v49
    v_add_f32 v48, v50, v51
    v_add_f32 v47, v47, v48
    v_mov_b32 v28, v46
    v_mov_b32 v29, v47
    v_mov_b32 v30, v12
    v_mov_b32 v31, v17

    s_cmp_ge_u32 s73, 1
    s_cbranch_scc1 L_spd_30
    s_mov_b32 s87, 0
L_sp_29:
    ds_read_b128 v[252:255], v14 offset:0
    s_waitcnt lgkmcnt(0)
    v_min_u32 v252, v252, v253
    v_min3_u32 v252, v252, v254, v255

    s_nop 0
    v_readfirstlane_b32 s73, v252
    s_add_u32 s87, s87, 1
    s_cmp_ge_u32 s73, 1
    s_cbranch_scc1 L_spd_30
    s_cmp_ge_u32 s87, 200000
    s_cbranch_scc1 L_spd_30
    s_sleep 1
    s_branch L_sp_29

L_spd_30:
    ds_read_b128 v[64:67], v41 offset:0
    ds_read_b64_tr_b16 v[68:69], v20 offset:0
    ds_read_b64_tr_b16 v[70:71], v20 offset:4096
    ds_read_b64_tr_b16 v[72:73], v22 offset:0
    ds_read_b64_tr_b16 v[74:75], v22 offset:4096
    ds_read_b128 v[76:79], v41 offset:64
    ds_read_b64_tr_b16 v[80:81], v20 offset:8192
    ds_read_b64_tr_b16 v[82:83], v20 offset:12288
    ds_read_b64_tr_b16 v[84:85], v22 offset:8192
    ds_read_b64_tr_b16 v[86:87], v22 offset:12288
    ds_read_b128 v[88:91], v41 offset:128
    ds_read_b64_tr_b16 v[92:93], v20 offset:16384
    ds_read_b64_tr_b16 v[94:95], v20 offset:20480
    ds_read_b64_tr_b16 v[96:97], v22 offset:16384
    ds_read_b64_tr_b16 v[98:99], v22 offset:20480
    ds_read_b128 v[100:103], v41 offset:192
    ds_read_b64_tr_b16 v[104:105], v20 offset:24576
    ds_read_b64_tr_b16 v[106:107], v20 offset:28672
    ds_read_b64_tr_b16 v[108:109], v22 offset:24576
    ds_read_b64_tr_b16 v[110:111], v22 offset:28672
    s_waitcnt lgkmcnt(15)
    v_mfma_f32_16x16x32_bf16 v[184:187], v[68:71], v[64:67], 0
    v_mfma_f32_16x16x32_bf16 v[188:191], v[72:75], v[64:67], 0
    s_waitcnt lgkmcnt(10)
    v_mfma_f32_16x16x32_bf16 v[184:187], v[80:83], v[76:79], v[184:187]
    v_mfma_f32_16x16x32_bf16 v[188:191], v[84:87], v[76:79], v[188:191]
    s_waitcnt lgkmcnt(5)
    v_mfma_f32_16x16x32_bf16 v[184:187], v[92:95], v[88:91], v[184:187]
    v_mfma_f32_16x16x32_bf16 v[188:191], v[96:99], v[88:91], v[188:191]
    s_waitcnt lgkmcnt(0)
    v_mfma_f32_16x16x32_bf16 v[184:187], v[104:107], v[100:103], v[184:187]
    v_mfma_f32_16x16x32_bf16 v[188:191], v[108:111], v[100:103], v[188:191]
    s_mov_b64 exec, 1
    ds_add_u32 v14, v15 offset:32
    s_mov_b64 exec, -1
    s_cmp_ge_u32 s73, 2
    s_cbranch_scc1 L_spd_32
    s_mov_b32 s87, 0
L_sp_31:
    ds_read_b128 v[252:255], v14 offset:0
    s_waitcnt lgkmcnt(0)
    v_min_u32 v252, v252, v253
    v_min3_u32 v252, v252, v254, v255

    s_nop 0
    v_readfirstlane_b32 s73, v252
    s_add_u32 s87, s87, 1
    s_cmp_ge_u32 s73, 2
    s_cbranch_scc1 L_spd_32
    s_cmp_ge_u32 s87, 200000
    s_cbranch_scc1 L_spd_32
    s_sleep 1
    s_branch L_sp_31

L_spd_32:
    ds_read_b128 v[64:67], v41 offset:256
    ds_read_b64_tr_b16 v[68:69], v20 offset:32768
    ds_read_b64_tr_b16 v[70:71], v20 offset:36864
    ds_read_b64_tr_b16 v[72:73], v22 offset:32768
    ds_read_b64_tr_b16 v[74:75], v22 offset:36864
    ds_read_b128 v[76:79], v41 offset:320
    ds_read_b64_tr_b16 v[80:81], v20 offset:40960
    ds_read_b64_tr_b16 v[82:83], v20 offset:45056
    ds_read_b64_tr_b16 v[84:85], v22 offset:40960
    ds_read_b64_tr_b16 v[86:87], v22 offset:45056
    ds_read_b128 v[88:91], v41 offset:384
    ds_read_b64_tr_b16 v[92:93], v20 offset:49152
    ds_read_b64_tr_b16 v[94:95], v20 offset:53248
    ds_read_b64_tr_b16 v[96:97], v22 offset:49152
    ds_read_b64_tr_b16 v[98:99], v22 offset:53248
    ds_read_b128 v[100:103], v41 offset:448
    ds_read_b64_tr_b16 v[104:105], v20 offset:57344
    ds_read_b64_tr_b16 v[106:107], v20 offset:61440
    ds_read_b64_tr_b16 v[108:109], v22 offset:57344
    ds_read_b64_tr_b16 v[110:111], v22 offset:61440
    s_waitcnt lgkmcnt(15)
    v_mfma_f32_16x16x32_bf16 v[184:187], v[68:71], v[64:67], v[184:187]
    v_mfma_f32_16x16x32_bf16 v[188:191], v[72:75], v[64:67], v[188:191]
    s_waitcnt lgkmcnt(10)
    v_mfma_f32_16x16x32_bf16 v[184:187], v[80:83], v[76:79], v[184:187]
    v_mfma_f32_16x16x32_bf16 v[188:191], v[84:87], v[76:79], v[188:191]
    s_waitcnt lgkmcnt(5)
    v_mfma_f32_16x16x32_bf16 v[184:187], v[92:95], v[88:91], v[184:187]
    v_mfma_f32_16x16x32_bf16 v[188:191], v[96:99], v[88:91], v[188:191]
    s_waitcnt lgkmcnt(0)
    v_mfma_f32_16x16x32_bf16 v[184:187], v[104:107], v[100:103], v[184:187]
    v_mfma_f32_16x16x32_bf16 v[188:191], v[108:111], v[100:103], v[188:191]
    s_cmp_ge_u32 s73, 3
    s_cbranch_scc1 L_spd_34
    s_mov_b32 s87, 0
L_sp_33:
    ds_read_b128 v[252:255], v14 offset:0
    s_waitcnt lgkmcnt(0)
    v_min_u32 v252, v252, v253
    v_min3_u32 v252, v252, v254, v255

    s_nop 0
    v_readfirstlane_b32 s73, v252
    s_add_u32 s87, s87, 1
    s_cmp_ge_u32 s73, 3
    s_cbranch_scc1 L_spd_34
    s_cmp_ge_u32 s87, 200000
    s_cbranch_scc1 L_spd_34
    s_sleep 1
    s_branch L_sp_33

L_spd_34:
    ds_read_b128 v[64:67], v41 offset:512
    ds_read_b64_tr_b16 v[68:69], v21 offset:0
    ds_read_b64_tr_b16 v[70:71], v21 offset:4096
    ds_read_b64_tr_b16 v[72:73], v23 offset:0
    ds_read_b64_tr_b16 v[74:75], v23 offset:4096
    ds_read_b128 v[76:79], v41 offset:576
    ds_read_b64_tr_b16 v[80:81], v21 offset:8192
    ds_read_b64_tr_b16 v[82:83], v21 offset:12288
    ds_read_b64_tr_b16 v[84:85], v23 offset:8192
    ds_read_b64_tr_b16 v[86:87], v23 offset:12288
    ds_read_b128 v[88:91], v41 offset:640
    ds_read_b64_tr_b16 v[92:93], v21 offset:16384
    ds_read_b64_tr_b16 v[94:95], v21 offset:20480
    ds_read_b64_tr_b16 v[96:97], v23 offset:16384
    ds_read_b64_tr_b16 v[98:99], v23 offset:20480
    ds_read_b128 v[100:103], v41 offset:704
    ds_read_b64_tr_b16 v[104:105], v21 offset:24576
    ds_read_b64_tr_b16 v[106:107], v21 offset:28672
    ds_read_b64_tr_b16 v[108:109], v23 offset:24576
    ds_read_b64_tr_b16 v[110:111], v23 offset:28672
    s_waitcnt lgkmcnt(15)
    v_mfma_f32_16x16x32_bf16 v[184:187], v[68:71], v[64:67], v[184:187]
    v_mfma_f32_16x16x32_bf16 v[188:191], v[72:75], v[64:67], v[188:191]
    s_waitcnt lgkmcnt(10)
    v_mfma_f32_16x16x32_bf16 v[184:187], v[80:83], v[76:79], v[184:187]
    v_mfma_f32_16x16x32_bf16 v[188:191], v[84:87], v[76:79], v[188:191]
    s_waitcnt lgkmcnt(5)
    v_mfma_f32_16x16x32_bf16 v[184:187], v[92:95], v[88:91], v[184:187]
    v_mfma_f32_16x16x32_bf16 v[188:191], v[96:99], v[88:91], v[188:191]
    s_waitcnt lgkmcnt(0)
    v_mfma_f32_16x16x32_bf16 v[184:187], v[104:107], v[100:103], v[184:187]
    v_mfma_f32_16x16x32_bf16 v[188:191], v[108:111], v[100:103], v[188:191]

    s_lshl_b32 s37, s32, 14
    s_lshl_b32 s34, s28, 12
    s_add_u32 s37, s37, s34
    s_add_u32 s37, s37, 524288
    s_lshl_b32 s38, s30, 11
    s_lshl_b32 s35, s28, 9
    s_add_u32 s38, s38, s35
    s_lshl_b32 s35, s29, 4
    s_add_u32 s38, s38, s35
    s_add_u32 s38, s38, 1048576
    v_lshrrev_b32 v33, 5, v1
    v_lshlrev_b32 v33, 6, v33
    s_lshl_b32 s33, s28, 8
    v_lshlrev_b32 v47, 2, v4
    v_add_u32 v47, v47, v3
    v_lshlrev_b32 v47, 4, v47
    v_add_u32 v47, s33, v47

    v_mov_b32 v24, v47
    s_lshl_b32 s35, s29, 10
    s_lshl_b32 s36, s75, 7
    s_add_u32 s35, s35, s36
    s_lshl_b32 s36, s28, 5
    s_add_u32 s35, s35, s36
    v_lshlrev_b32 v25, 3, v4
    buffer_load_dwordx2 v[26:27], v25, s[40:43], s35 offen

    s_cmp_ge_u32 s73, 4
    s_cbranch_scc1 L_spd_36
    s_mov_b32 s87, 0
L_sp_35:
    ds_read_b128 v[252:255], v14 offset:0
    s_waitcnt lgkmcnt(0)
    v_min_u32 v252, v252, v253
    v_min3_u32 v252, v252, v254, v255

    s_nop 0
    v_readfirstlane_b32 s73, v252
    s_add_u32 s87, s87, 1
    s_cmp_ge_u32 s73, 4
    s_cbranch_scc1 L_spd_36
    s_cmp_ge_u32 s87, 200000
    s_cbranch_scc1 L_spd_36
    s_sleep 1
    s_branch L_sp_35

L_spd_36:

    s_cmp_lg_u32 s28, 0
    s_cbranch_scc1 L_mlst_early
    s_mov_b64 exec, 15
    buffer_store_dwordx4 v[28:31], v5, s[68:71], s60 offen sc1
    s_mov_b64 exec, -1

L_mlst_early:
    ds_read_b128 v[64:67], v41 offset:768
    ds_read_b64_tr_b16 v[68:69], v21 offset:32768
    ds_read_b64_tr_b16 v[70:71], v21 offset:36864
    ds_read_b64_tr_b16 v[72:73], v23 offset:32768
    ds_read_b64_tr_b16 v[74:75], v23 offset:36864
    ds_read_b128 v[76:79], v41 offset:832
    ds_read_b64_tr_b16 v[80:81], v21 offset:40960
    ds_read_b64_tr_b16 v[82:83], v21 offset:45056
    ds_read_b64_tr_b16 v[84:85], v23 offset:40960
    ds_read_b64_tr_b16 v[86:87], v23 offset:45056
    s_waitcnt lgkmcnt(5)
    v_mfma_f32_16x16x32_bf16 v[184:187], v[68:71], v[64:67], v[184:187]
    v_mfma_f32_16x16x32_bf16 v[188:191], v[72:75], v[64:67], v[188:191]
    s_waitcnt lgkmcnt(0)
    v_mfma_f32_16x16x32_bf16 v[184:187], v[80:83], v[76:79], v[184:187]
    v_mfma_f32_16x16x32_bf16 v[188:191], v[84:87], v[76:79], v[188:191]
    s_cmp_ge_u32 s73, 5
    s_cbranch_scc1 L_spd_38
    s_mov_b32 s87, 0
L_sp_37:
    ds_read_b128 v[252:255], v14 offset:0
    s_waitcnt lgkmcnt(0)
    v_min_u32 v252, v252, v253
    v_min3_u32 v252, v252, v254, v255

    s_nop 0
    v_readfirstlane_b32 s73, v252
    s_add_u32 s87, s87, 1
    s_cmp_ge_u32 s73, 5
    s_cbranch_scc1 L_spd_38
    s_cmp_ge_u32 s87, 200000
    s_cbranch_scc1 L_spd_38
    s_sleep 1
    s_branch L_sp_37

L_spd_38:
    ds_read_b128 v[88:91], v41 offset:896
    ds_read_b64_tr_b16 v[92:93], v21 offset:49152
    ds_read_b64_tr_b16 v[94:95], v21 offset:53248
    ds_read_b64_tr_b16 v[96:97], v23 offset:49152
    ds_read_b64_tr_b16 v[98:99], v23 offset:53248
    ds_read_b128 v[100:103], v41 offset:960
    ds_read_b64_tr_b16 v[104:105], v21 offset:57344
    ds_read_b64_tr_b16 v[106:107], v21 offset:61440
    ds_read_b64_tr_b16 v[108:109], v23 offset:57344
    ds_read_b64_tr_b16 v[110:111], v23 offset:61440
    s_waitcnt lgkmcnt(5)
    v_mfma_f32_16x16x32_bf16 v[184:187], v[92:95], v[88:91], v[184:187]
    v_mfma_f32_16x16x32_bf16 v[188:191], v[96:99], v[88:91], v[188:191]
    s_waitcnt lgkmcnt(0)
    v_mfma_f32_16x16x32_bf16 v[184:187], v[104:107], v[100:103], v[184:187]
    v_mfma_f32_16x16x32_bf16 v[188:191], v[108:111], v[100:103], v[188:191]
    s_nop 7
    v_bfi_b32 v184, v7, v6, v184
    v_bfi_b32 v185, v7, v8, v185
    v_bfi_b32 v186, v7, v9, v186
    v_bfi_b32 v187, v7, v10, v187
    v_bfi_b32 v188, v7, v6, v188
    v_bfi_b32 v189, v7, v8, v189
    v_bfi_b32 v190, v7, v9, v190
    v_bfi_b32 v191, v7, v10, v191

    s_mov_b64 exec, s[80:81]
    buffer_store_dwordx4 v[184:187], v11, s[68:71], s66 offen sc1
    buffer_store_dwordx4 v[188:191], v11, s[68:71], s66 offen offset:64 sc1
    s_mov_b64 exec, -1

    s_mov_b32 s35, 0x3fb8aa3b
    buffer_load_dwordx4 v[192:195], v33, s[68:71], s38 offen offset:0 sc1
    buffer_load_dwordx4 v[196:199], v33, s[68:71], s38 offen offset:128 sc1
    buffer_load_dwordx4 v[200:203], v33, s[68:71], s38 offen offset:256 sc1
    buffer_load_dwordx4 v[204:207], v33, s[68:71], s38 offen offset:384 sc1
    s_mov_b32 s86, 0
L_ml_loop:
    s_waitcnt vmcnt(0)
    v_xor_b32 v36, v194, v12
    v_bitop3_b32 v36, v36, v195, v17 bitop3:0xf6
    v_bitop3_b32 v36, v36, v198, v12 bitop3:0xf6
    v_bitop3_b32 v36, v36, v199, v17 bitop3:0xf6
    v_bitop3_b32 v36, v36, v202, v12 bitop3:0xf6
    v_bitop3_b32 v36, v36, v203, v17 bitop3:0xf6
    v_bitop3_b32 v36, v36, v206, v12 bitop3:0xf6
    v_bitop3_b32 v36, v36, v207, v17 bitop3:0xf6
    v_cmp_ne_u32 vcc, 0, v36
    s_cbranch_vccz L_ml_ok0
    buffer_load_dwordx4 v[192:195], v33, s[68:71], s38 offen offset:0 sc1
    buffer_load_dwordx4 v[196:199], v33, s[68:71], s38 offen offset:128 sc1
    buffer_load_dwordx4 v[200:203], v33, s[68:71], s38 offen offset:256 sc1
    buffer_load_dwordx4 v[204:207], v33, s[68:71], s38 offen offset:384 sc1

    s_add_u32 s86, s86, 1
    s_cmp_lt_u32 s86, 20000
    s_cbranch_scc1 L_ml_loop
    s_waitcnt vmcnt(0)

L_ml_ok0:
    buffer_load_dwordx4 v[128:131], v5, s[68:71], s37 offen offset:0 sc1
    buffer_load_dwordx4 v[132:135], v5, s[68:71], s37 offen offset:1024 sc1
    buffer_load_dwordx4 v[136:139], v5, s[68:71], s37 offen offset:2048 sc1
    buffer_load_dwordx4 v[140:143], v5, s[68:71], s37 offen offset:3072 sc1

    v_max3_f32 v36, v192, v196, v200
    v_max_f32 v36, v36, v204

    v_mov_b32 v37, v36
    s_nop 1
    v_permlane32_swap_b32 v36, v37
    s_nop 0
    v_max_f32 v36, v36, v37
    v_sub_f32 v49, v192, v36
    v_sub_f32 v50, v196, v36
    v_sub_f32 v51, v200, v36
    v_sub_f32 v52, v204, v36
    v_mul_f32 v49, s35, v49
    v_mul_f32 v50, s35, v50
    v_mul_f32 v51, s35, v51
    v_mul_f32 v52, s35, v52
    v_exp_f32 v49, v49
    v_exp_f32 v50, v50
    v_exp_f32 v51, v51
    v_exp_f32 v52, v52
    s_nop 0
    v_mul_f32 v48, v49, v193
    v_fmac_f32 v48, v50, v197
    v_fmac_f32 v48, v51, v201
    v_fmac_f32 v48, v52, v205
L_ml_done:
    s_mov_b32 s87, 0
L_sp_39:
    ds_read_b32 v252, v14 offset:28
    s_waitcnt lgkmcnt(0)

    s_nop 0
    v_readfirstlane_b32 s39, v252
    s_add_u32 s87, s87, 1
    s_cmp_ge_u32 s39, 4
    s_cbranch_scc1 L_spd_40
    s_cmp_ge_u32 s87, 200000
    s_cbranch_scc1 L_spd_40
    s_sleep 1
    s_branch L_sp_39

L_spd_40:
    ds_read_b128 v[168:171], v24 offset:9664
    s_cmp_ge_u32 s73, 6
    s_cbranch_scc1 L_spd_42
    s_mov_b32 s87, 0
L_sp_41:
    ds_read_b128 v[252:255], v14 offset:0
    s_waitcnt lgkmcnt(0)
    v_min_u32 v252, v252, v253
    v_min3_u32 v252, v252, v254, v255

    s_nop 0
    v_readfirstlane_b32 s73, v252
    s_add_u32 s87, s87, 1
    s_cmp_ge_u32 s73, 6
    s_cbranch_scc1 L_spd_42
    s_cmp_ge_u32 s87, 200000
    s_cbranch_scc1 L_spd_42
    s_sleep 1
    s_branch L_sp_41

L_spd_42:
    ds_read_b64_tr_b16 v[152:153], v34 offset:0
    ds_read_b64_tr_b16 v[154:155], v34 offset:512
    ds_read_b64_tr_b16 v[156:157], v34 offset:4096
    ds_read_b64_tr_b16 v[158:159], v34 offset:4608
    ds_read_b64_tr_b16 v[160:161], v34 offset:8192
    ds_read_b64_tr_b16 v[162:163], v34 offset:8704
    ds_read_b64_tr_b16 v[164:165], v34 offset:12288
    ds_read_b64_tr_b16 v[166:167], v34 offset:12800
    v_mov_b32 v37, v48
    s_nop 1
    v_permlane32_swap_b32 v48, v37
    s_nop 0
    v_add_f32 v48, v48, v37
    v_rcp_f32 v48, v48
    s_nop 0
    v_mul_f32 v49, v49, v48
    v_mul_f32 v50, v50, v48
    v_mul_f32 v51, v51, v48
    v_mul_f32 v52, v52, v48
    s_mov_b32 s86, 0
    s_waitcnt vmcnt(0)
L_ap_chk:
    v_xor_b32 v128, v128, v6
    v_xor_b32 v129, v129, v8
    v_xor_b32 v130, v130, v9
    v_xor_b32 v131, v131, v10
    v_xor_b32 v132, v132, v6
    v_xor_b32 v133, v133, v8
    v_xor_b32 v134, v134, v9
    v_xor_b32 v135, v135, v10
    v_xor_b32 v136, v136, v6
    v_xor_b32 v137, v137, v8
    v_xor_b32 v138, v138, v9
    v_xor_b32 v139, v139, v10
    v_xor_b32 v140, v140, v6
    v_xor_b32 v141, v141, v8
    v_xor_b32 v142, v142, v9
    v_xor_b32 v143, v143, v10
    v_or3_b32 v36, v128, v129, v130
    v_or3_b32 v36, v36, v131, v132
    v_or3_b32 v36, v36, v133, v134
    v_or3_b32 v36, v36, v135, v136
    v_or3_b32 v36, v36, v137, v138
    v_or3_b32 v36, v36, v139, v140
    v_or3_b32 v36, v36, v141, v142
    v_or_b32 v36, v36, v143
    v_and_b32 v36, v36, v7
    v_cmp_ne_u32 vcc, 0, v36

    s_cbranch_vccz L_ap_ok
    s_add_u32 s86, s86, 1
    s_cmp_ge_u32 s86, 20000
    s_cbranch_scc1 L_ap_ok

    buffer_load_dwordx4 v[128:131], v5, s[68:71], s37 offen offset:0 sc1
    buffer_load_dwordx4 v[132:135], v5, s[68:71], s37 offen offset:1024 sc1
    buffer_load_dwordx4 v[136:139], v5, s[68:71], s37 offen offset:2048 sc1
    buffer_load_dwordx4 v[140:143], v5, s[68:71], s37 offen offset:3072 sc1
    s_waitcnt vmcnt(0)
    s_branch L_ap_chk
L_ap_ok:
    v_mul_f32 v44, v49, v128
    v_mul_f32 v45, v49, v129
    v_mul_f32 v46, v49, v130
    v_mul_f32 v47, v49, v131
    v_fmac_f32 v44, v50, v132
    v_fmac_f32 v45, v50, v133
    v_fmac_f32 v46, v50, v134
    v_fmac_f32 v47, v50, v135
    v_fmac_f32 v44, v51, v136
    v_fmac_f32 v45, v51, v137
    v_fmac_f32 v46, v51, v138
    v_fmac_f32 v47, v51, v139
    v_fmac_f32 v44, v52, v140
    v_fmac_f32 v45, v52, v141
    v_fmac_f32 v46, v52, v142
    v_fmac_f32 v47, v52, v143
    v_mov_b32 v36, v44
    v_mov_b32 v37, v45
    v_mov_b32 v38, v46
    v_mov_b32 v39, v47
    s_nop 1
    v_permlane32_swap_b32 v44, v36
    v_permlane32_swap_b32 v45, v37
    v_permlane32_swap_b32 v46, v38
    v_permlane32_swap_b32 v47, v39
    s_nop 0
    v_add_f32 v44, v44, v36
    v_add_f32 v45, v45, v37
    v_add_f32 v46, v46, v38
    v_add_f32 v47, v47, v39

    v_cvt_pk_bf16_f32 v42, v44, v45
    v_cvt_pk_bf16_f32 v43, v46, v47
    s_mul_i32 s35, s28, 272
    v_lshlrev_b32 v41, 3, v1
    v_add_u32 v41, s35, v41
    s_mov_b32 exec_lo, -1
    s_mov_b32 exec_hi, 0
    ds_write_b64 v41, v[42:43] offset:7488
    s_mov_b64 exec, -1

    s_waitcnt lgkmcnt(0)
    s_barrier
    ds_read_b128 v[172:175], v35 offset:7488
    ds_read_b128 v[176:179], v35 offset:7552
    ds_read_b128 v[180:183], v35 offset:7616
    ds_read_b128 v[184:187], v35 offset:7680
    s_waitcnt lgkmcnt(3)
    v_mfma_f32_16x16x32_bf16 v[168:171], v[152:155], v[172:175], v[168:171]
    s_waitcnt lgkmcnt(2)
    v_mfma_f32_16x16x32_bf16 v[168:171], v[156:159], v[176:179], v[168:171]
    s_waitcnt lgkmcnt(1)
    v_mfma_f32_16x16x32_bf16 v[168:171], v[160:163], v[180:183], v[168:171]
    s_waitcnt lgkmcnt(0)
    v_mfma_f32_16x16x32_bf16 v[168:171], v[164:167], v[184:187], v[168:171]
    s_nop 7
    v_bfi_b32 v168, v7, v6, v168
    v_bfi_b32 v169, v7, v8, v169
    v_bfi_b32 v170, v7, v9, v170
    v_bfi_b32 v171, v7, v10, v171

    s_mov_b64 exec, s[80:81]

    s_add_u32 s33, s67, 262144
    buffer_store_dwordx4 v[168:171], v13, s[68:71], s33 offen

    buffer_store_dwordx4 v[168:171], v13, s[68:71], s67 offen sc1
    s_mov_b64 exec, -1

    s_cmp_lg_u32 s30, 0
    s_cbranch_scc1 L_end
    s_lshl_b32 s33, s75, 2
    s_add_u32 s33, s33, s29
    s_lshl_b32 s33, s33, 13
    s_lshl_b32 s34, s28, 6
    s_add_u32 s33, s33, s34
    s_add_u32 s33, s33, 1114112
    s_add_u32 s34, s33, 4096
    s_lshl_b32 s35, s29, 10
    s_lshl_b32 s36, s75, 7
    s_add_u32 s35, s35, s36
    s_lshl_b32 s36, s28, 5
    s_add_u32 s35, s35, s36
    v_lshrrev_b32 v32, 2, v1
    v_lshlrev_b32 v32, 8, v32
    v_lshl_add_u32 v32, v4, 4, v32
    v_lshlrev_b32 v33, 3, v4

    s_add_u32 s37, s33, 262144
    s_add_u32 s38, s34, 262144
    buffer_load_dwordx4 v[224:227], v32, s[68:71], s37 offen sc1
    buffer_load_dwordx4 v[228:231], v32, s[68:71], s38 offen sc1
    buffer_load_dwordx4 v[240:243], v32, s[68:71], s37 offen sc1
    buffer_load_dwordx4 v[244:247], v32, s[68:71], s38 offen sc1
    s_mov_b32 s86, 0
L_fa_loop:
    s_waitcnt vmcnt(2)
    v_xor_b32 v224, v224, v6
    v_xor_b32 v225, v225, v8
    v_xor_b32 v226, v226, v9
    v_xor_b32 v227, v227, v10
    v_xor_b32 v228, v228, v6
    v_xor_b32 v229, v229, v8
    v_xor_b32 v230, v230, v9
    v_xor_b32 v231, v231, v10
    v_or3_b32 v38, v224, v225, v226
    v_or3_b32 v38, v38, v227, v228
    v_or3_b32 v38, v38, v229, v230
    v_or_b32 v38, v38, v231
    v_and_b32 v38, v38, v7
    v_cmp_ne_u32 vcc, 0, v38
    s_cbranch_vccz L_fin_ok0
    buffer_load_dwordx4 v[224:227], v32, s[68:71], s37 offen sc1
    buffer_load_dwordx4 v[228:231], v32, s[68:71], s38 offen sc1
    s_waitcnt vmcnt(2)
    v_xor_b32 v240, v240, v6
    v_xor_b32 v241, v241, v8
    v_xor_b32 v242, v242, v9
    v_xor_b32 v243, v243, v10
    v_xor_b32 v244, v244, v6
    v_xor_b32 v245, v245, v8
    v_xor_b32 v246, v246, v9
    v_xor_b32 v247, v247, v10
    v_or3_b32 v38, v240, v241, v242
    v_or3_b32 v38, v38, v243, v244
    v_or3_b32 v38, v38, v245, v246
    v_or_b32 v38, v38, v247
    v_and_b32 v38, v38, v7
    v_cmp_ne_u32 vcc, 0, v38
    s_cbranch_vccz L_fin_ok2
    buffer_load_dwordx4 v[240:243], v32, s[68:71], s37 offen sc1
    buffer_load_dwordx4 v[244:247], v32, s[68:71], s38 offen sc1

    s_add_u32 s86, s86, 1
    s_cmp_lt_u32 s86, 10
    s_cbranch_scc1 L_fa_loop
    s_waitcnt vmcnt(0)

    buffer_load_dwordx4 v[224:227], v32, s[68:71], s37 offen sc1
    buffer_load_dwordx4 v[228:231], v32, s[68:71], s38 offen sc1
    buffer_load_dwordx4 v[232:235], v32, s[68:71], s33 offen sc1
    buffer_load_dwordx4 v[236:239], v32, s[68:71], s34 offen sc1
    s_mov_b32 s86, 0
L_fin_loop:
    s_waitcnt vmcnt(2)
    v_xor_b32 v224, v224, v6
    v_xor_b32 v225, v225, v8
    v_xor_b32 v226, v226, v9
    v_xor_b32 v227, v227, v10
    v_xor_b32 v228, v228, v6
    v_xor_b32 v229, v229, v8
    v_xor_b32 v230, v230, v9
    v_xor_b32 v231, v231, v10
    v_or3_b32 v38, v224, v225, v226
    v_or3_b32 v38, v38, v227, v228
    v_or3_b32 v38, v38, v229, v230
    v_or_b32 v38, v38, v231
    v_and_b32 v38, v38, v7
    v_cmp_ne_u32 vcc, 0, v38
    s_cbranch_vccz L_fin_ok0
    buffer_load_dwordx4 v[224:227], v32, s[68:71], s37 offen sc1
    buffer_load_dwordx4 v[228:231], v32, s[68:71], s38 offen sc1
    s_waitcnt vmcnt(2)
    v_xor_b32 v232, v232, v6
    v_xor_b32 v233, v233, v8
    v_xor_b32 v234, v234, v9
    v_xor_b32 v235, v235, v10
    v_xor_b32 v236, v236, v6
    v_xor_b32 v237, v237, v8
    v_xor_b32 v238, v238, v9
    v_xor_b32 v239, v239, v10
    v_or3_b32 v38, v232, v233, v234
    v_or3_b32 v38, v38, v235, v236
    v_or3_b32 v38, v38, v237, v238
    v_or_b32 v38, v38, v239
    v_and_b32 v38, v38, v7
    v_cmp_ne_u32 vcc, 0, v38
    s_cbranch_vccz L_fin_ok1
    buffer_load_dwordx4 v[232:235], v32, s[68:71], s33 offen sc1
    buffer_load_dwordx4 v[236:239], v32, s[68:71], s34 offen sc1

    s_add_u32 s86, s86, 1
    s_cmp_lt_u32 s86, 20000
    s_cbranch_scc1 L_fin_loop
    s_waitcnt vmcnt(0)

L_fin_ok0:
    v_add_f32 v44, v224, v228
    v_add_f32 v45, v225, v229
    v_add_f32 v46, v226, v230
    v_add_f32 v47, v227, v231
    s_branch L_fin_done
L_fin_ok1:
    v_add_f32 v44, v232, v236
    v_add_f32 v45, v233, v237
    v_add_f32 v46, v234, v238
    v_add_f32 v47, v235, v239
    s_branch L_fin_done
L_fin_ok2:
    v_add_f32 v44, v240, v244
    v_add_f32 v45, v241, v245
    v_add_f32 v46, v242, v246
    v_add_f32 v47, v243, v247
L_fin_done:
    s_nop 1
    v_add_f32_dpp v44, v44, v44 row_ror:4 row_mask:0xf bank_mask:0xf
    v_add_f32_dpp v45, v45, v45 row_ror:4 row_mask:0xf bank_mask:0xf
    v_add_f32_dpp v46, v46, v46 row_ror:4 row_mask:0xf bank_mask:0xf
    v_add_f32_dpp v47, v47, v47 row_ror:4 row_mask:0xf bank_mask:0xf
    s_nop 1
    v_add_f32_dpp v44, v44, v44 row_ror:8 row_mask:0xf bank_mask:0xf
    v_add_f32_dpp v45, v45, v45 row_ror:8 row_mask:0xf bank_mask:0xf
    v_add_f32_dpp v46, v46, v46 row_ror:8 row_mask:0xf bank_mask:0xf
    v_add_f32_dpp v47, v47, v47 row_ror:8 row_mask:0xf bank_mask:0xf
    s_nop 0
    v_mov_b32 v38, v44
    v_mov_b32 v39, v45
    v_mov_b32 v40, v46
    v_mov_b32 v41, v47
    s_nop 1
    v_permlane16_swap_b32 v44, v38
    v_permlane16_swap_b32 v45, v39
    v_permlane16_swap_b32 v46, v40
    v_permlane16_swap_b32 v47, v41
    s_nop 0
    v_add_f32 v44, v44, v38
    v_add_f32 v45, v45, v39
    v_add_f32 v46, v46, v40
    v_add_f32 v47, v47, v41
    v_mov_b32 v38, v44
    v_mov_b32 v39, v45
    v_mov_b32 v40, v46
    v_mov_b32 v41, v47
    s_nop 1
    v_permlane32_swap_b32 v44, v38
    v_permlane32_swap_b32 v45, v39
    v_permlane32_swap_b32 v46, v40
    v_permlane32_swap_b32 v47, v41
    s_nop 0
    v_add_f32 v44, v44, v38
    v_add_f32 v45, v45, v39
    v_add_f32 v46, v46, v40
    v_add_f32 v47, v47, v41

    v_lshlrev_b32 v40, 16, v26
    v_and_b32 v41, 0xffff0000, v26
    v_lshlrev_b32 v42, 16, v27
    v_and_b32 v43, 0xffff0000, v27
    v_add_f32 v40, v40, v44
    v_add_f32 v41, v41, v45
    v_add_f32 v42, v42, v46
    v_add_f32 v43, v43, v47
    v_cvt_pk_bf16_f32 v40, v40, v41
    v_cvt_pk_bf16_f32 v41, v42, v43
    s_mov_b64 exec, 15
    buffer_store_dwordx2 v[40:41], v33, s[76:79], s35 offen
    s_mov_b64 exec, -1
    s_cmp_lg_u32 s28, 0
    s_cbranch_scc1 L_end
    s_cmp_lg_u32 s2, 0
    s_cbranch_scc1 L_end
    s_add_u32 s72, s72, 1
    v_mov_b32 v40, s72
    v_mov_b32 v41, 0
    s_mov_b32 s34, 2031616
    s_mov_b64 exec, 1
    buffer_store_dword v40, v41, s[68:71], s34 offen sc1
    s_mov_b64 exec, -1

L_end:
L_exit:
    s_endpgm
.section .rodata,"a"
.p2align 6
.amdhsa_kernel parallel_sum__gqa_block_cached__glu_gated_geglu__decode_kernel
  .amdhsa_next_free_vgpr 256
  .amdhsa_next_free_sgpr 102
  .amdhsa_accum_offset 256
  .amdhsa_group_segment_fixed_size 0
  .amdhsa_kernarg_size 96
  .amdhsa_user_sgpr_count 2
  .amdhsa_user_sgpr_kernarg_segment_ptr 1
  .amdhsa_system_sgpr_workgroup_id_x 1
.end_amdhsa_kernel
```
